```python
import torch

def _softmax(x, axis=-1):
    return torch.softmax(x, dim=axis)
def _gelu(x):
    return torch.nn.functional.gelu(x, approximate="tanh")
def _silu(x):
    return torch.nn.functional.silu(x)
def _sigmoid(x):
    return torch.sigmoid(x)
def _layernorm(x, axis=-1, eps=1e-5):
    m = x.mean(dim=axis, keepdim=True)
    v = x.var(dim=axis, keepdim=True, unbiased=False)
    return (x - m) / torch.sqrt(v + eps)
def _scatter_add(tgt, idx, src, axis=0):
    return tgt.clone().index_add_(axis, idx, src)
def _segment_sum(src, seg, n):
    out = torch.zeros((n,) + src.shape[1:], dtype=src.dtype)
    return out.index_add_(0, seg, src)
def _pad(x, pw):
    flat = tuple(v for pair in reversed(pw) for v in pair)
    return torch.nn.functional.pad(x, flat)

kernel_name = 'recurrent_scan__gqa_block_cached__mixer_channel_mlp__decode'

def setup_inputs():

    _w = (lambda a: (lambda t: t.to(torch.bfloat16) if t.is_floating_point() else t)(torch.as_tensor(a)))
    def _A_setup():
        B, Sq, D = 1, 1, 512
        Hq, Hkv, Sk, Dh = 32, 32, 8192, 128
        assert Hq % Hkv == 0, (Hq, Hkv)
        return {
            "x": _w((lambda *s: torch.randn(*s, dtype=torch.bfloat16) * 0.1)(B, Sq, D)),
            "k_cache": _w((lambda *s: torch.randn(*s, dtype=torch.bfloat16) * 0.8)(B, Hkv, Sk, Dh)),
            "v_cache": _w((lambda *s: torch.randn(*s, dtype=torch.bfloat16) * 3.2)(B, Hkv, Sk, Dh)),
            "wq": _w((lambda *s: torch.randn(*s, dtype=torch.bfloat16) * 0.8)(D, Hq * Dh) * (D ** -0.5)),
            "wo": _w((lambda *s: torch.randn(*s, dtype=torch.bfloat16) * 3.2)(Hq * Dh, D) * ((Hq * Dh) ** -0.5)),
        }
    _A_in = _A_setup()

    def _B_setup():
        B, S, D, F = 1, 1, 512, 1376
        return {
            "x": _w((lambda *s: torch.randn(*s, dtype=torch.bfloat16) * 0.1)(B, S, D)),
            "w1": _w((lambda *s: torch.randn(*s, dtype=torch.bfloat16) * 3.2)(D, F) * (D ** -0.5)),
            "b1": _w((lambda *s: torch.randn(*s, dtype=torch.bfloat16) * 3.2)(F)),
            "w2": _w((lambda *s: torch.randn(*s, dtype=torch.bfloat16) * 3.2)(F, D) * (F ** -0.5)),
            "b2": _w((lambda *s: torch.randn(*s, dtype=torch.bfloat16) * 3.2)(D)),
        }
    _B_in = _B_setup()

    return {
        "A_x": _A_in["x"],
        "A_k_cache": _A_in["k_cache"],
        "A_v_cache": _A_in["v_cache"],
        "A_wq": _A_in["wq"],
        "A_wo": _A_in["wo"],
        "B_x": _B_in["x"],
        "B_w1": _B_in["w1"],
        "B_b1": _B_in["b1"],
        "B_w2": _B_in["w2"],
        "B_b2": _B_in["b2"],
    }

def reference(A_x, A_k_cache, A_v_cache, A_wq, A_wo, B_x, B_w1, B_b1, B_w2, B_b2):
    def _A_ref(x, k_cache, v_cache, wq, wo):
        B, Sq, D = x.shape
        Hq, Dh = 32, 128
        Hkv = k_cache.shape[1]
        rep = Hq // Hkv
        q = (lambda x, *d: x.permute(*d))((x @ wq).reshape(B, Sq, Hq, Dh), 0, 2, 1, 3)
        k = (lambda x, n, axis: torch.repeat_interleave(x, n, dim=axis))(k_cache, rep, axis=1)
        v = (lambda x, n, axis: torch.repeat_interleave(x, n, dim=axis))(v_cache, rep, axis=1)
        scores = torch.einsum("bhqd,bhkd->bhqk", q, k) * (Dh ** -0.5)
        p = _softmax(scores, axis=-1)
        o = torch.einsum("bhqk,bhkd->bhqd", p, v)
        return (lambda x, *d: x.permute(*d))(o, 0, 2, 1, 3).reshape(B, Sq, Hq * Dh) @ wo

    def _B_ref(x, w1, b1, w2, b2):
        y = _layernorm(x, axis=-1)
        h = _gelu(torch.einsum("bsd,df->bsf", y, w1) + b1)
        return torch.einsum("bsf,fd->bsd", h, w2) + b2

    x = A_x
    xn = _layernorm(x, axis=-1)
    s = _A_ref(xn, A_k_cache, A_v_cache, A_wq, A_wo)
    g = _silu(_B_ref(xn, B_w1, B_b1, B_w2, B_b2))
    return x + s * g
```

```asm
; @launch grid=(256,1,1) block=(512,1,1) lds=48384
.amdgcn_target "amdgcn-amd-amdhsa--gfx950"
.text
.globl recurrent_scan__gqa_block_cached__mixer_channel_mlp__decode_kernel
.p2align 8
.type recurrent_scan__gqa_block_cached__mixer_channel_mlp__decode_kernel,@function
recurrent_scan__gqa_block_cached__mixer_channel_mlp__decode_kernel:
    s_cmp_ge_u32 s2, 256

    s_cbranch_scc1 L_end
    s_load_dwordx16 s[64:79], s[0:1], 0
    s_load_dwordx8 s[80:87], s[0:1], 64
    s_load_dwordx2 s[88:89], s[0:1], 96

    v_lshrrev_b32 v3, 6, v0
    v_and_b32 v0, 63, v0
    v_readfirstlane_b32 s3, v3
    s_lshr_b32 s4, s2, 3
    s_and_b32 s5, s2, 7
    v_lshrrev_b32 v3, 4, v0
    v_bfe_u32 v4, v0, 2, 2
    v_and_b32 v5, 3, v0
    s_add_u32 s63, s4, s5
    s_add_u32 s63, s63, s3
    s_and_b32 s63, s63, 7
    v_lshlrev_b32 v1, 6, v3
    v_lshl_add_u32 v1, v4, 8, v1
    v_lshl_add_u32 v1, v5, 4, v1
    s_mov_b32 s59, s63
    s_lshl_b32 s52, s59, 12

    s_lshl_b32 s63, s2, 18
    s_lshl_b32 s90, s3, 15
    s_add_u32 s90, s90, s63
    s_waitcnt lgkmcnt(0)
    s_add_u32 s8, s66, s90
    s_addc_u32 s9, s67, 0
    s_and_b32 s9, s9, 0xffff
    s_mov_b32 s10, 0x00008000
    s_mov_b32 s11, 0x20000
    buffer_load_dwordx4 v[128:131], v1, s[8:11], s52 offen offset:0 nt
    buffer_load_dwordx4 v[132:135], v1, s[8:11], s52 offen offset:1024 nt
    buffer_load_dwordx4 v[136:139], v1, s[8:11], s52 offen offset:2048 nt
    buffer_load_dwordx4 v[140:143], v1, s[8:11], s52 offen offset:3072 nt

    v_mov_b32 v8, 0
    v_mov_b32 v9, 0
    v_mov_b32 v10, 0
    v_mov_b32 v11, 0
    ds_write_b128 v8, v[8:11] offset:48320

    v_lshlrev_b32 v2, 4, v0
    v_lshlrev_b32 v122, 1, v3
    v_lshrrev_b32 v116, 3, v0
    s_xor_b32 s53, s59, 1
    s_lshl_b32 s53, s53, 12
    s_xor_b32 s54, s59, 2
    s_lshl_b32 s54, s54, 12
    s_xor_b32 s55, s59, 3
    s_lshl_b32 s55, s55, 12
    s_xor_b32 s56, s59, 4
    s_lshl_b32 s56, s56, 12
    s_xor_b32 s57, s59, 5
    s_lshl_b32 s57, s57, 12
    s_xor_b32 s58, s59, 6
    s_lshl_b32 s58, s58, 12
    s_xor_b32 s59, s59, 7
    s_lshl_b32 s59, s59, 12
    s_waitcnt lgkmcnt(0)
    s_add_u32 s12, s68, s90
    s_addc_u32 s13, s69, 0
    s_and_b32 s13, s13, 0xffff
    s_mov_b32 s14, 0x00008000
    s_mov_b32 s15, 0x20000
    s_barrier

    s_setprio 3
    s_mul_i32 s7, s4, 172
    s_add_u32 s6, s7, 172
    s_lshr_b32 s7, s7, 5
    s_lshr_b32 s6, s6, 5
    s_sub_u32 s6, s6, s7
    s_lshl_b32 s60, s5, 6
    s_lshl_b32 s63, s3, 3
    s_add_u32 s60, s60, s63
    v_lshlrev_b32 v123, 1, v116
    s_mov_b32 s16, s64
    s_and_b32 s17, s65, 0xffff
    s_mov_b32 s18, 0x00000400
    s_mov_b32 s19, 0x20000
    s_mov_b32 s36, s88
    s_and_b32 s37, s89, 0xffff
    s_mov_b32 s38, 0x00200000
    s_mov_b32 s39, 0x20000
    s_cmp_lg_u32 s3, 0
    s_cbranch_scc1 L_noextra
    s_lshl_b32 s63, s7, 4
    s_add_u32 s40, s78, s63
    s_addc_u32 s41, s79, 0
    s_and_b32 s41, s41, 0xffff
    s_mov_b32 s42, 0x00000000
    s_mov_b32 s43, 0x20000
    s_sub_u32 s42, 2752, s63
    s_mov_b32 s44, s82
    s_and_b32 s45, s83, 0xffff
    s_mov_b32 s46, 0x00000400
    s_mov_b32 s47, 0x20000

    v_mov_b32 v62, 0
    v_lshlrev_b32 v63, 1, v0
    v_lshrrev_b32 v124, 5, v0
    v_lshlrev_b32 v124, 1, v124
    s_lshl_b32 s63, s2, 2
    buffer_load_dword v48, v62, s[36:39], 0 offen sc1
    buffer_load_ushort v49, v63, s[40:43], 0 offen
    buffer_load_ushort v50, v124, s[16:19], s63 offen
    buffer_load_ushort v51, v124, s[44:47], s63 offen
L_noextra:
    s_lshl_b32 s63, s60, 1
    buffer_load_dwordx4 v[64:67], v2, s[16:19], 0 offen
    buffer_load_ushort v104, v122, s[16:19], s63 offen
    buffer_load_ushort v105, v122, s[16:19], s63 offen offset:8
    buffer_load_ushort v106, v123, s[16:19], s63 offen
    buffer_load_ushort v100, v122, s[16:19], s63 offen offset:136
    buffer_load_ushort v101, v122, s[16:19], s63 offen offset:128
    buffer_load_ushort v102, v123, s[16:19], s63 offen offset:128

    v_and_b32 v118, 15, v0
    v_lshlrev_b32 v119, 13, v3
    v_lshl_add_u32 v119, v118, 4, v119
    s_lshl_b32 s63, s60, 13
    s_lshl_b32 s90, s4, 8
    s_add_u32 s63, s63, s90
    s_mov_b32 s61, 32768
    s_mov_b32 s62, 8192
    s_add_u32 s20, s70, s63
    s_addc_u32 s21, s71, 0
    s_and_b32 s21, s21, 0xffff
    s_mov_b32 s22, 0x0008e100
    s_mov_b32 s23, 0x20000
    s_bitcmp1_b32 s5, 0
    s_cselect_b32 s22, 0, s22
    s_mov_b32 s91, 0x00088000
    s_mov_b32 s90, 0x00080000
    buffer_load_dwordx4 v[80:83], v119, s[20:23], 0 offen nt
    buffer_load_dwordx4 v[84:87], v119, s[20:23], s61 offen nt
    buffer_load_dwordx4 v[92:95], v119, s[20:23], s91 offen nt
    buffer_load_dwordx4 v[96:99], v119, s[20:23], s90 offen nt

    v_and_b32 v117, 7, v0
    v_mul_u32_u24 v120, 0xac0, v116
    v_lshl_add_u32 v120, v117, 4, v120
    v_cmp_gt_u32 vcc, s6, v117
    v_mov_b32 v121, 0x40000000
    s_mul_i32 s63, s60, 2752
    s_lshl_b32 s90, s7, 4
    s_add_u32 s63, s63, s90
    v_cndmask_b32 v120, v121, v120, vcc
    s_add_u32 s24, s76, s63
    s_addc_u32 s25, s77, 0
    s_and_b32 s25, s25, 0xffff
    s_mov_b32 s26, 0x0002fba0
    s_mov_b32 s27, 0x20000
    s_bitcmp1_b32 s5, 0
    s_cselect_b32 s26, 0, s26
    s_mov_b32 s90, 0x0002b000
    buffer_load_dwordx4 v[88:91], v120, s[24:27], 0 offen nt
    buffer_load_dwordx4 v[76:79], v120, s[24:27], s90 offen nt
    buffer_load_dwordx4 v[144:147], v1, s[8:11], s53 offen offset:0 nt
    buffer_load_dwordx4 v[148:151], v1, s[8:11], s53 offen offset:1024 nt
    buffer_load_dwordx4 v[152:155], v1, s[8:11], s53 offen offset:2048 nt
    buffer_load_dwordx4 v[156:159], v1, s[8:11], s53 offen offset:3072 nt
    buffer_load_dwordx4 v[160:163], v1, s[8:11], s54 offen offset:0 nt
    buffer_load_dwordx4 v[164:167], v1, s[8:11], s54 offen offset:1024 nt
    buffer_load_dwordx4 v[168:171], v1, s[8:11], s54 offen offset:2048 nt
    buffer_load_dwordx4 v[172:175], v1, s[8:11], s54 offen offset:3072 nt
    buffer_load_dwordx4 v[176:179], v1, s[8:11], s55 offen offset:0 nt
    buffer_load_dwordx4 v[180:183], v1, s[8:11], s55 offen offset:1024 nt
    buffer_load_dwordx4 v[184:187], v1, s[8:11], s55 offen offset:2048 nt
    buffer_load_dwordx4 v[188:191], v1, s[8:11], s55 offen offset:3072 nt
    buffer_load_dwordx4 v[192:195], v1, s[8:11], s56 offen offset:0 nt
    buffer_load_dwordx4 v[196:199], v1, s[8:11], s56 offen offset:1024 nt
    buffer_load_dwordx4 v[200:203], v1, s[8:11], s56 offen offset:2048 nt
    buffer_load_dwordx4 v[204:207], v1, s[8:11], s56 offen offset:3072 nt

    v_lshlrev_b32 v7, 10, v3
    v_lshl_add_u32 v7, v4, 7, v7
    v_lshl_add_u32 v7, v5, 3, v7
    v_lshlrev_b32 v6, 10, v116
    v_lshl_add_u32 v6, v117, 4, v6

    s_lshl_b32 s63, s4, 17
    s_lshl_b32 s90, s3, 14
    s_add_u32 s63, s63, s90
    s_lshl_b32 s90, s5, 7
    s_add_u32 s63, s63, s90
    s_add_u32 s28, s72, s63
    s_addc_u32 s29, s73, 0
    s_and_b32 s29, s29, 0xffff
    s_mov_b32 s30, 0x00003c80
    s_mov_b32 s31, 0x20000

    s_add_u32 s63, s7, s3
    s_lshl_b32 s63, s63, 13
    s_lshl_b32 s90, s5, 7
    s_add_u32 s63, s63, s90
    s_add_u32 s32, s80, s63
    s_addc_u32 s33, s81, 0
    s_and_b32 s33, s33, 0xffff
    s_mov_b32 s34, 0x00001c80
    s_mov_b32 s35, 0x20000
    s_cmp_lt_u32 s3, s6
    s_cselect_b32 s34, s34, 0
    s_mov_b32 s48, s84
    s_and_b32 s49, s85, 0xffff
    s_mov_b32 s50, 0x00000400
    s_mov_b32 s51, 0x20000

    s_lshl_b32 s63, s2, 10
    s_add_u32 s64, s63, 0x00001000
    s_add_u32 s67, s63, 0x00041000
    s_add_u32 s71, s63, 0x00081000
    s_lshl_b32 s63, s4, 13
    s_add_u32 s65, s63, 0x00001000
    s_add_u32 s66, s63, 0x00002000
    s_add_u32 s68, s63, 0x00041000
    s_add_u32 s69, s63, 0x00042000
    s_lshl_b32 s63, s5, 15
    s_lshl_b32 s90, s4, 4
    s_add_u32 s63, s63, s90
    s_add_u32 s70, s63, 0x00081000
    s_mov_b32 s86, 0x3e0293ee
    s_mov_b32 s72, 0x000f000f
    s_mov_b32 s73, 0x000f000f
    s_mov_b32 s74, 0x00f000f0
    s_mov_b32 s75, 0x00f000f0
    s_mov_b32 s76, 0x0f000f00
    s_mov_b32 s77, 0x0f000f00
    s_mov_b32 s78, 0xf000f000
    s_mov_b32 s79, 0xf000f000

    s_mov_b32 s80, 0xffff0000
    s_mov_b32 s81, 0
    s_mov_b32 s82, 0
    s_mov_b32 s83, 0x0000ffff
    s_mov_b32 s84, 0
    s_mov_b32 s85, 0xffff0000

    v_and_b32 v3, 1, v0
    v_bfe_u32 v4, v0, 1, 2
    v_mov_b32 v5, 0xffff
    v_lshlrev_b32 v3, 4, v3
    v_lshlrev_b32 v5, v3, v5
    v_cmp_eq_u32 vcc, 0, v4
    s_nop 1
    v_cndmask_b32 v28, 0, v5, vcc
    v_cmp_eq_u32 vcc, 1, v4
    s_nop 1
    v_cndmask_b32 v29, 0, v5, vcc
    v_cmp_eq_u32 vcc, 2, v4
    s_nop 1
    v_cndmask_b32 v30, 0, v5, vcc
    v_cmp_eq_u32 vcc, 3, v4
    s_nop 1
    v_cndmask_b32 v31, 0, v5, vcc

    v_lshrrev_b32 v3, 4, v0
    v_and_b32 v4, 7, v0
    v_lshl_add_u32 v107, v3, 5, v4
    v_and_b32 v5, 1, v3
    v_lshl_add_u32 v5, v5, 5, v4
    v_lshrrev_b32 v3, 1, v3
    v_mul_u32_u24 v3, 9216, v3
    s_mul_i32 s63, s3, 1152
    v_mul_u32_u24 v62, 171, v107
    v_mul_u32_u24 v63, 171, v5
    v_add_u32 v116, 0, v62
    v_lshrrev_b32 v116, 9, v116
    v_add_u32 v116, v116, v107
    v_lshl_add_u32 v116, v116, 2, s63
    v_add_u32 v120, 0, v63
    v_lshrrev_b32 v120, 9, v120
    v_add_u32 v120, v120, v5
    v_lshl_add_u32 v120, v120, 2, s63
    v_add_u32 v120, v120, v3
    v_add_u32 v117, 1368, v62
    v_lshrrev_b32 v117, 9, v117
    v_add_u32 v117, v117, v107
    v_lshl_add_u32 v117, v117, 2, s63
    v_add_u32 v121, 1368, v63
    v_lshrrev_b32 v121, 9, v121
    v_add_u32 v121, v121, v5
    v_lshl_add_u32 v121, v121, 2, s63
    v_add_u32 v121, v121, v3
    v_add_u32 v118, 2736, v62
    v_lshrrev_b32 v118, 9, v118
    v_add_u32 v118, v118, v107
    v_lshl_add_u32 v118, v118, 2, s63
    v_add_u32 v122, 2736, v63
    v_lshrrev_b32 v122, 9, v122
    v_add_u32 v122, v122, v5
    v_lshl_add_u32 v122, v122, 2, s63
    v_add_u32 v122, v122, v3
    v_add_u32 v119, 4104, v62
    v_lshrrev_b32 v119, 9, v119
    v_add_u32 v119, v119, v107
    v_lshl_add_u32 v119, v119, 2, s63
    v_add_u32 v123, 4104, v63
    v_lshrrev_b32 v123, 9, v123
    v_add_u32 v123, v123, v5
    v_lshl_add_u32 v123, v123, 2, s63
    v_add_u32 v123, v123, v3
    s_waitcnt vmcnt(22)
    v_lshlrev_b32 v68, 16, v64
    v_and_b32 v69, 0xffff0000, v64
    v_lshlrev_b32 v70, 16, v65
    v_and_b32 v71, 0xffff0000, v65
    v_lshlrev_b32 v72, 16, v66
    v_and_b32 v73, 0xffff0000, v66
    v_lshlrev_b32 v74, 16, v67
    v_and_b32 v75, 0xffff0000, v67

    v_add_f32 v8, v68, v69
    v_add_f32 v9, v70, v71
    v_add_f32 v10, v72, v73
    v_add_f32 v11, v74, v75
    v_add_f32 v8, v8, v9
    v_add_f32 v10, v10, v11
    v_add_f32 v8, v8, v10
    s_nop 1
    v_add_f32_dpp v8, v8, v8 row_ror:1 row_mask:0xf bank_mask:0xf
    s_nop 1
    v_add_f32_dpp v8, v8, v8 row_ror:2 row_mask:0xf bank_mask:0xf
    s_nop 1
    v_add_f32_dpp v8, v8, v8 row_ror:4 row_mask:0xf bank_mask:0xf
    s_nop 1
    v_add_f32_dpp v8, v8, v8 row_ror:8 row_mask:0xf bank_mask:0xf
    s_nop 1
    v_add_f32_dpp v8, v8, v8 row_bcast:15 row_mask:0xa bank_mask:0xf
    s_nop 1
    v_add_f32_dpp v8, v8, v8 row_bcast:31 row_mask:0xc bank_mask:0xf
    s_nop 1
    v_readlane_b32 s88, v8, 63
    s_nop 1

    v_mov_b32 v12, s88
    v_mul_f32 v12, 0x3b000000, v12
    v_sub_f32 v13, v68, v12
    v_sub_f32 v14, v69, v12
    v_sub_f32 v15, v70, v12
    v_sub_f32 v16, v71, v12
    v_sub_f32 v17, v72, v12
    v_sub_f32 v18, v73, v12
    v_sub_f32 v19, v74, v12
    v_sub_f32 v20, v75, v12
    v_mul_f32 v8, v13, v13
    v_mul_f32 v9, v14, v14
    v_fmac_f32 v8, v15, v15
    v_fmac_f32 v9, v16, v16
    v_fmac_f32 v8, v17, v17
    v_fmac_f32 v9, v18, v18
    v_fmac_f32 v8, v19, v19
    v_fmac_f32 v9, v20, v20
    v_add_f32 v8, v8, v9
    s_nop 1
    v_add_f32_dpp v8, v8, v8 row_ror:1 row_mask:0xf bank_mask:0xf
    s_nop 1
    v_add_f32_dpp v8, v8, v8 row_ror:2 row_mask:0xf bank_mask:0xf
    s_nop 1
    v_add_f32_dpp v8, v8, v8 row_ror:4 row_mask:0xf bank_mask:0xf
    s_nop 1
    v_add_f32_dpp v8, v8, v8 row_ror:8 row_mask:0xf bank_mask:0xf
    s_nop 1
    v_add_f32_dpp v8, v8, v8 row_bcast:15 row_mask:0xa bank_mask:0xf
    s_nop 1
    v_add_f32_dpp v8, v8, v8 row_bcast:31 row_mask:0xc bank_mask:0xf
    s_nop 1
    v_readlane_b32 s88, v8, 63
    s_nop 1
    v_mov_b32 v8, s88
    v_mul_f32 v8, 0x3b000000, v8
    v_cvt_pk_bf16_f32 v8, v8, v8
    v_and_b32 v8, 0xffff0000, v8
    v_add_f32 v8, 0x3727c5ac, v8
    v_cvt_pk_bf16_f32 v8, v8, v8
    v_and_b32 v8, 0xffff0000, v8
    v_sqrt_f32 v8, v8
    s_nop 0
    v_cvt_pk_bf16_f32 v8, v8, v8
    v_and_b32 v8, 0xffff0000, v8
    v_rcp_f32 v8, v8
    v_cvt_pk_bf16_f32 v12, v12, v12
    v_and_b32 v12, 0xffff0000, v12
    s_nop 0
    v_readfirstlane_b32 s91, v8
    v_readfirstlane_b32 s90, v12
    s_nop 1
    v_subrev_f32 v68, s90, v68
    v_cvt_pk_bf16_f32 v68, v68, v68
    v_and_b32 v68, 0xffff0000, v68
    v_mul_f32 v68, s91, v68
    v_cvt_pk_bf16_f32 v68, v68, v68
    v_and_b32 v68, 0xffff0000, v68
    v_subrev_f32 v69, s90, v69
    v_cvt_pk_bf16_f32 v69, v69, v69
    v_and_b32 v69, 0xffff0000, v69
    v_mul_f32 v69, s91, v69
    v_cvt_pk_bf16_f32 v69, v69, v69
    v_and_b32 v69, 0xffff0000, v69
    v_subrev_f32 v70, s90, v70
    v_cvt_pk_bf16_f32 v70, v70, v70
    v_and_b32 v70, 0xffff0000, v70
    v_mul_f32 v70, s91, v70
    v_cvt_pk_bf16_f32 v70, v70, v70
    v_and_b32 v70, 0xffff0000, v70
    v_subrev_f32 v71, s90, v71
    v_cvt_pk_bf16_f32 v71, v71, v71
    v_and_b32 v71, 0xffff0000, v71
    v_mul_f32 v71, s91, v71
    v_cvt_pk_bf16_f32 v71, v71, v71
    v_and_b32 v71, 0xffff0000, v71
    v_subrev_f32 v72, s90, v72
    v_cvt_pk_bf16_f32 v72, v72, v72
    v_and_b32 v72, 0xffff0000, v72
    v_mul_f32 v72, s91, v72
    v_cvt_pk_bf16_f32 v72, v72, v72
    v_and_b32 v72, 0xffff0000, v72
    v_subrev_f32 v73, s90, v73
    v_cvt_pk_bf16_f32 v73, v73, v73
    v_and_b32 v73, 0xffff0000, v73
    v_mul_f32 v73, s91, v73
    v_cvt_pk_bf16_f32 v73, v73, v73
    v_and_b32 v73, 0xffff0000, v73
    v_subrev_f32 v74, s90, v74
    v_cvt_pk_bf16_f32 v74, v74, v74
    v_and_b32 v74, 0xffff0000, v74
    v_mul_f32 v74, s91, v74
    v_cvt_pk_bf16_f32 v74, v74, v74
    v_and_b32 v74, 0xffff0000, v74
    v_subrev_f32 v75, s90, v75
    v_cvt_pk_bf16_f32 v75, v75, v75
    v_and_b32 v75, 0xffff0000, v75
    v_mul_f32 v75, s91, v75
    v_cvt_pk_bf16_f32 v75, v75, v75
    v_and_b32 v75, 0xffff0000, v75
    v_lshlrev_b32 v104, 16, v104
    v_subrev_f32 v104, s90, v104
    v_cvt_pk_bf16_f32 v104, v104, v104
    v_and_b32 v104, 0xffff0000, v104
    v_mul_f32 v104, s91, v104
    v_cvt_pk_bf16_f32 v104, v104, v104
    v_and_b32 v104, 0xffff0000, v104
    v_lshlrev_b32 v105, 16, v105
    v_subrev_f32 v105, s90, v105
    v_cvt_pk_bf16_f32 v105, v105, v105
    v_and_b32 v105, 0xffff0000, v105
    v_mul_f32 v105, s91, v105
    v_cvt_pk_bf16_f32 v105, v105, v105
    v_and_b32 v105, 0xffff0000, v105
    v_lshlrev_b32 v106, 16, v106
    v_subrev_f32 v106, s90, v106
    v_cvt_pk_bf16_f32 v106, v106, v106
    v_and_b32 v106, 0xffff0000, v106
    v_mul_f32 v106, s91, v106
    v_cvt_pk_bf16_f32 v106, v106, v106
    v_and_b32 v106, 0xffff0000, v106
    v_cvt_pk_bf16_f32 v104, v104, v104
    v_cvt_pk_bf16_f32 v105, v105, v105
    v_lshlrev_b32 v100, 16, v100
    v_subrev_f32 v100, s90, v100
    v_cvt_pk_bf16_f32 v100, v100, v100
    v_and_b32 v100, 0xffff0000, v100
    v_mul_f32 v100, s91, v100
    v_cvt_pk_bf16_f32 v100, v100, v100
    v_and_b32 v100, 0xffff0000, v100
    v_cvt_pk_bf16_f32 v100, v100, v100
    v_lshlrev_b32 v101, 16, v101
    v_subrev_f32 v101, s90, v101
    v_cvt_pk_bf16_f32 v101, v101, v101
    v_and_b32 v101, 0xffff0000, v101
    v_mul_f32 v101, s91, v101
    v_cvt_pk_bf16_f32 v101, v101, v101
    v_and_b32 v101, 0xffff0000, v101
    v_cvt_pk_bf16_f32 v101, v101, v101
    v_lshlrev_b32 v102, 16, v102
    v_subrev_f32 v102, s90, v102
    v_cvt_pk_bf16_f32 v102, v102, v102
    v_and_b32 v102, 0xffff0000, v102
    v_mul_f32 v102, s91, v102
    v_cvt_pk_bf16_f32 v102, v102, v102
    v_and_b32 v102, 0xffff0000, v102
    buffer_load_dwordx4 v[208:211], v1, s[8:11], s57 offen offset:0 nt
    buffer_load_dwordx4 v[212:215], v1, s[8:11], s57 offen offset:1024 nt
    buffer_load_dwordx4 v[216:219], v1, s[8:11], s57 offen offset:2048 nt
    buffer_load_dwordx4 v[220:223], v1, s[8:11], s57 offen offset:3072 nt
    buffer_load_dwordx4 v[224:227], v1, s[8:11], s58 offen offset:0 nt
    buffer_load_dwordx4 v[228:231], v1, s[8:11], s58 offen offset:1024 nt
    buffer_load_dwordx4 v[232:235], v1, s[8:11], s58 offen offset:2048 nt
    buffer_load_dwordx4 v[236:239], v1, s[8:11], s58 offen offset:3072 nt
    v_and_b32 v32, v104, v28
    v_and_b32 v33, v104, v29
    v_and_b32 v34, v104, v30
    v_and_b32 v35, v104, v31
    v_and_b32 v36, v105, v28
    v_and_b32 v37, v105, v29
    v_and_b32 v38, v105, v30
    v_and_b32 v39, v105, v31
    v_and_b32 v40, v100, v28
    v_and_b32 v44, v101, v28
    v_and_b32 v41, v100, v29
    v_and_b32 v45, v101, v29
    v_and_b32 v42, v100, v30
    v_and_b32 v46, v101, v30
    v_and_b32 v43, v100, v31
    v_and_b32 v47, v101, v31
    s_waitcnt vmcnt(26)

    s_nop 1
    v_mfma_f32_16x16x32_bf16 v[108:111], v[80:83], v[32:35], 0
    v_mfma_f32_16x16x32_bf16 v[108:111], v[84:87], v[36:39], v[108:111]
    v_mfma_f32_16x16x32_bf16 v[108:111], v[92:95], v[40:43], v[108:111]
    v_mfma_f32_16x16x32_bf16 v[108:111], v[96:99], v[44:47], v[108:111]

    v_add_f32 v8, v68, v69
    v_add_f32 v9, v70, v71
    v_add_f32 v10, v72, v73
    v_add_f32 v11, v74, v75
    v_add_f32 v8, v8, v9
    v_add_f32 v10, v10, v11
    v_add_f32 v8, v8, v10
    s_nop 1
    v_add_f32_dpp v8, v8, v8 row_ror:1 row_mask:0xf bank_mask:0xf
    s_nop 1
    v_add_f32_dpp v8, v8, v8 row_ror:2 row_mask:0xf bank_mask:0xf
    s_nop 1
    v_add_f32_dpp v8, v8, v8 row_ror:4 row_mask:0xf bank_mask:0xf
    s_nop 1
    v_add_f32_dpp v8, v8, v8 row_ror:8 row_mask:0xf bank_mask:0xf
    s_nop 1
    v_add_f32_dpp v8, v8, v8 row_bcast:15 row_mask:0xa bank_mask:0xf
    s_nop 1
    v_add_f32_dpp v8, v8, v8 row_bcast:31 row_mask:0xc bank_mask:0xf
    s_nop 1
    v_readlane_b32 s88, v8, 63
    s_nop 1

    v_mov_b32 v12, s88
    v_mul_f32 v12, 0x3b000000, v12
    v_sub_f32 v13, v68, v12
    v_sub_f32 v14, v69, v12
    v_sub_f32 v15, v70, v12
    v_sub_f32 v16, v71, v12
    v_sub_f32 v17, v72, v12
    v_sub_f32 v18, v73, v12
    v_sub_f32 v19, v74, v12
    v_sub_f32 v20, v75, v12
    v_mul_f32 v8, v13, v13
    v_mul_f32 v9, v14, v14
    v_fmac_f32 v8, v15, v15
    v_fmac_f32 v9, v16, v16
    v_fmac_f32 v8, v17, v17
    v_fmac_f32 v9, v18, v18
    v_fmac_f32 v8, v19, v19
    v_fmac_f32 v9, v20, v20
    v_add_f32 v8, v8, v9
    s_nop 1
    v_add_f32_dpp v8, v8, v8 row_ror:1 row_mask:0xf bank_mask:0xf
    s_nop 1
    v_add_f32_dpp v8, v8, v8 row_ror:2 row_mask:0xf bank_mask:0xf
    s_nop 1
    v_add_f32_dpp v8, v8, v8 row_ror:4 row_mask:0xf bank_mask:0xf
    s_nop 1
    v_add_f32_dpp v8, v8, v8 row_ror:8 row_mask:0xf bank_mask:0xf
    s_nop 1
    v_add_f32_dpp v8, v8, v8 row_bcast:15 row_mask:0xa bank_mask:0xf
    s_nop 1
    v_add_f32_dpp v8, v8, v8 row_bcast:31 row_mask:0xc bank_mask:0xf
    s_nop 1
    v_readlane_b32 s88, v8, 63
    s_nop 1
    v_mov_b32 v8, s88
    v_mul_f32 v8, 0x3b000000, v8
    v_cvt_pk_bf16_f32 v8, v8, v8
    v_and_b32 v8, 0xffff0000, v8
    v_add_f32 v8, 0x3727c5ac, v8
    v_cvt_pk_bf16_f32 v8, v8, v8
    v_and_b32 v8, 0xffff0000, v8
    v_sqrt_f32 v8, v8
    s_nop 0
    v_cvt_pk_bf16_f32 v8, v8, v8
    v_and_b32 v8, 0xffff0000, v8
    v_rcp_f32 v8, v8
    v_cvt_pk_bf16_f32 v12, v12, v12
    v_and_b32 v12, 0xffff0000, v12
    s_nop 0
    v_readfirstlane_b32 s91, v8
    v_readfirstlane_b32 s90, v12
    s_nop 1
    v_subrev_f32 v106, s90, v106
    v_cvt_pk_bf16_f32 v106, v106, v106
    v_and_b32 v106, 0xffff0000, v106
    v_mul_f32 v106, s91, v106
    v_cvt_pk_bf16_f32 v106, v106, v106
    v_and_b32 v106, 0xffff0000, v106
    v_cvt_pk_bf16_f32 v106, v106, v106
    v_subrev_f32 v102, s90, v102
    v_cvt_pk_bf16_f32 v102, v102, v102
    v_and_b32 v102, 0xffff0000, v102
    v_mul_f32 v102, s91, v102
    v_cvt_pk_bf16_f32 v102, v102, v102
    v_and_b32 v102, 0xffff0000, v102
    v_cvt_pk_bf16_f32 v102, v102, v102
    v_and_b32 v32, v106, v28
    v_and_b32 v36, v102, v28
    v_and_b32 v33, v106, v29
    v_and_b32 v37, v102, v29
    v_and_b32 v34, v106, v30
    v_and_b32 v38, v102, v30
    v_and_b32 v35, v106, v31
    v_and_b32 v39, v102, v31
    s_waitcnt vmcnt(24)

    s_nop 0
    v_mfma_f32_16x16x32_bf16 v[112:115], v[88:91], v[32:35], 0
    v_mfma_f32_16x16x32_bf16 v[112:115], v[76:79], v[36:39], v[112:115]
    ds_write_b32 v116, v108 offset:0
    ds_write_b32 v117, v109 offset:32
    ds_write_b32 v118, v110 offset:64
    ds_write_b32 v119, v111 offset:96

    s_nop 3
    s_mov_b32 exec_lo, 0x00ff00ff
    s_mov_b32 exec_hi, 0xff00ff00
    ds_write_b32 v120, v112 offset:688
    ds_write_b32 v121, v113 offset:720
    ds_write_b32 v122, v114 offset:752
    ds_write_b32 v123, v115 offset:784

    s_mov_b64 exec, 1
    v_mov_b32 v3, 0
    v_mov_b32 v4, 1
    s_waitcnt lgkmcnt(0)
    ds_add_u32 v3, v4 offset:48328
    s_mov_b64 exec, -1
    buffer_load_dwordx4 v[240:243], v1, s[8:11], s59 offen offset:0 nt
    buffer_load_dwordx4 v[244:247], v1, s[8:11], s59 offen offset:1024 nt
    buffer_load_dwordx4 v[248:251], v1, s[8:11], s59 offen offset:2048 nt
    buffer_load_dwordx4 v[252:255], v1, s[8:11], s59 offen offset:3072 nt
    s_cmp_eq_u32 s3, 0
    s_cbranch_scc1 L_path0
    s_waitcnt vmcnt(11)
    s_setprio 2
    buffer_load_dwordx4 v[64:67], v2, s[12:15], s52 offen offset:0 nt
    s_waitcnt vmcnt(11)
    buffer_load_dwordx4 v[68:71], v2, s[12:15], s52 offen offset:1024 nt
    s_waitcnt vmcnt(11)
    buffer_load_dwordx4 v[72:75], v2, s[12:15], s52 offen offset:2048 nt
    s_waitcnt vmcnt(11)
    buffer_load_dwordx4 v[76:79], v2, s[12:15], s52 offen offset:3072 nt
    s_waitcnt vmcnt(11)
    buffer_load_dwordx4 v[80:83], v2, s[12:15], s53 offen offset:0 nt
    s_waitcnt vmcnt(11)
    buffer_load_dwordx4 v[84:87], v2, s[12:15], s53 offen offset:1024 nt
    s_waitcnt vmcnt(11)
    buffer_load_dwordx4 v[88:91], v2, s[12:15], s53 offen offset:2048 nt
    s_waitcnt vmcnt(11)
    buffer_load_dwordx4 v[92:95], v2, s[12:15], s53 offen offset:3072 nt
    s_waitcnt vmcnt(11)
    buffer_load_dwordx4 v[96:99], v2, s[12:15], s54 offen offset:0 nt
    s_waitcnt vmcnt(11)
    buffer_load_dwordx4 v[100:103], v2, s[12:15], s54 offen offset:1024 nt
    s_waitcnt vmcnt(11)
    buffer_load_dwordx4 v[104:107], v2, s[12:15], s54 offen offset:2048 nt
    s_waitcnt vmcnt(11)
    buffer_load_dwordx4 v[108:111], v2, s[12:15], s54 offen offset:3072 nt
    s_waitcnt vmcnt(11)
    s_setprio 1
    buffer_load_dwordx4 v[112:115], v2, s[12:15], s55 offen offset:0 nt
    s_waitcnt vmcnt(11)
    buffer_load_dwordx4 v[116:119], v2, s[12:15], s55 offen offset:1024 nt
    s_waitcnt vmcnt(11)
    buffer_load_dwordx4 v[120:123], v2, s[12:15], s55 offen offset:2048 nt
    s_waitcnt vmcnt(11)
    buffer_load_dwordx4 v[124:127], v2, s[12:15], s55 offen offset:3072 nt
    s_waitcnt vmcnt(16)

    s_mov_b32 s87, 0
Lx_flag_spin:
    v_mov_b32 v3, 0
    ds_read_b32 v3, v3 offset:48320
    s_add_u32 s87, s87, 1
    s_waitcnt lgkmcnt(0)
    v_readfirstlane_b32 s88, v3
    s_cmp_eq_u32 s88, 1
    s_cbranch_scc1 Lx_flag_ok
    s_sleep 1
    s_cmp_lt_u32 s87, 0x100000
    s_cbranch_scc1 Lx_flag_spin
Lx_flag_ok:

    v_lshrrev_b32 v3, 4, v0
    v_lshlrev_b32 v3, 6, v3
    v_and_b32 v4, 3, v0
    v_lshl_add_u32 v3, v4, 4, v3
    ds_read_b128 v[12:15], v3 offset:47104
    s_waitcnt lgkmcnt(0)
    v_cndmask_b32_e64 v32, 0, v12, s[72:73]
    v_cndmask_b32_e64 v33, 0, v13, s[72:73]
    v_cndmask_b32_e64 v34, 0, v14, s[72:73]
    v_cndmask_b32_e64 v35, 0, v15, s[72:73]
    v_cndmask_b32_e64 v36, 0, v12, s[74:75]
    v_cndmask_b32_e64 v37, 0, v13, s[74:75]
    v_cndmask_b32_e64 v38, 0, v14, s[74:75]
    v_cndmask_b32_e64 v39, 0, v15, s[74:75]
    v_cndmask_b32_e64 v40, 0, v12, s[76:77]
    v_cndmask_b32_e64 v41, 0, v13, s[76:77]
    v_cndmask_b32_e64 v42, 0, v14, s[76:77]
    v_cndmask_b32_e64 v43, 0, v15, s[76:77]
    v_cndmask_b32_e64 v44, 0, v12, s[78:79]
    v_cndmask_b32_e64 v45, 0, v13, s[78:79]
    v_cndmask_b32_e64 v46, 0, v14, s[78:79]
    v_cndmask_b32_e64 v47, 0, v15, s[78:79]
    s_nop 1
    v_mfma_f32_16x16x32_bf16 v[12:15], v[128:131], v[32:35], 0
    v_mfma_f32_16x16x32_bf16 v[12:15], v[132:135], v[36:39], v[12:15]
    v_mfma_f32_16x16x32_bf16 v[12:15], v[136:139], v[40:43], v[12:15]
    v_mfma_f32_16x16x32_bf16 v[12:15], v[140:143], v[44:47], v[12:15]
    v_mfma_f32_16x16x32_bf16 v[16:19], v[144:147], v[32:35], 0
    v_mfma_f32_16x16x32_bf16 v[16:19], v[148:151], v[36:39], v[16:19]
    v_mfma_f32_16x16x32_bf16 v[16:19], v[152:155], v[40:43], v[16:19]
    v_mfma_f32_16x16x32_bf16 v[16:19], v[156:159], v[44:47], v[16:19]
    s_nop 3
    v_mov_b32_dpp v20, v12 quad_perm:[0,0,0,0] row_mask:0xf bank_mask:0xf
    v_add_f32_dpp v20, v13, v20 quad_perm:[1,1,1,1] row_mask:0xf bank_mask:0xf
    v_add_f32_dpp v20, v14, v20 quad_perm:[2,2,2,2] row_mask:0xf bank_mask:0xf
    v_add_f32_dpp v20, v15, v20 quad_perm:[3,3,3,3] row_mask:0xf bank_mask:0xf
    v_mfma_f32_16x16x32_bf16 v[12:15], v[160:163], v[32:35], 0
    v_mfma_f32_16x16x32_bf16 v[12:15], v[164:167], v[36:39], v[12:15]
    v_mfma_f32_16x16x32_bf16 v[12:15], v[168:171], v[40:43], v[12:15]
    v_mfma_f32_16x16x32_bf16 v[12:15], v[172:175], v[44:47], v[12:15]
    s_nop 3
    v_mov_b32_dpp v21, v16 quad_perm:[0,0,0,0] row_mask:0xf bank_mask:0xf
    v_add_f32_dpp v21, v17, v21 quad_perm:[1,1,1,1] row_mask:0xf bank_mask:0xf
    v_add_f32_dpp v21, v18, v21 quad_perm:[2,2,2,2] row_mask:0xf bank_mask:0xf
    v_add_f32_dpp v21, v19, v21 quad_perm:[3,3,3,3] row_mask:0xf bank_mask:0xf
    v_mfma_f32_16x16x32_bf16 v[16:19], v[176:179], v[32:35], 0
    v_mfma_f32_16x16x32_bf16 v[16:19], v[180:183], v[36:39], v[16:19]
    v_mfma_f32_16x16x32_bf16 v[16:19], v[184:187], v[40:43], v[16:19]
    v_mfma_f32_16x16x32_bf16 v[16:19], v[188:191], v[44:47], v[16:19]
    s_nop 3
    v_mov_b32_dpp v22, v12 quad_perm:[0,0,0,0] row_mask:0xf bank_mask:0xf
    v_add_f32_dpp v22, v13, v22 quad_perm:[1,1,1,1] row_mask:0xf bank_mask:0xf
    v_add_f32_dpp v22, v14, v22 quad_perm:[2,2,2,2] row_mask:0xf bank_mask:0xf
    v_add_f32_dpp v22, v15, v22 quad_perm:[3,3,3,3] row_mask:0xf bank_mask:0xf
    v_mfma_f32_16x16x32_bf16 v[12:15], v[192:195], v[32:35], 0
    v_mfma_f32_16x16x32_bf16 v[12:15], v[196:199], v[36:39], v[12:15]
    v_mfma_f32_16x16x32_bf16 v[12:15], v[200:203], v[40:43], v[12:15]
    v_mfma_f32_16x16x32_bf16 v[12:15], v[204:207], v[44:47], v[12:15]
    s_nop 3
    v_mov_b32_dpp v23, v16 quad_perm:[0,0,0,0] row_mask:0xf bank_mask:0xf
    v_add_f32_dpp v23, v17, v23 quad_perm:[1,1,1,1] row_mask:0xf bank_mask:0xf
    v_add_f32_dpp v23, v18, v23 quad_perm:[2,2,2,2] row_mask:0xf bank_mask:0xf
    v_add_f32_dpp v23, v19, v23 quad_perm:[3,3,3,3] row_mask:0xf bank_mask:0xf
    v_mfma_f32_16x16x32_bf16 v[16:19], v[208:211], v[32:35], 0
    v_mfma_f32_16x16x32_bf16 v[16:19], v[212:215], v[36:39], v[16:19]
    v_mfma_f32_16x16x32_bf16 v[16:19], v[216:219], v[40:43], v[16:19]
    v_mfma_f32_16x16x32_bf16 v[16:19], v[220:223], v[44:47], v[16:19]
    s_nop 3
    v_mov_b32_dpp v24, v12 quad_perm:[0,0,0,0] row_mask:0xf bank_mask:0xf
    v_add_f32_dpp v24, v13, v24 quad_perm:[1,1,1,1] row_mask:0xf bank_mask:0xf
    v_add_f32_dpp v24, v14, v24 quad_perm:[2,2,2,2] row_mask:0xf bank_mask:0xf
    v_add_f32_dpp v24, v15, v24 quad_perm:[3,3,3,3] row_mask:0xf bank_mask:0xf
    v_mfma_f32_16x16x32_bf16 v[12:15], v[224:227], v[32:35], 0
    v_mfma_f32_16x16x32_bf16 v[12:15], v[228:231], v[36:39], v[12:15]
    v_mfma_f32_16x16x32_bf16 v[12:15], v[232:235], v[40:43], v[12:15]
    v_mfma_f32_16x16x32_bf16 v[12:15], v[236:239], v[44:47], v[12:15]
    s_nop 3
    v_mov_b32_dpp v25, v16 quad_perm:[0,0,0,0] row_mask:0xf bank_mask:0xf
    v_add_f32_dpp v25, v17, v25 quad_perm:[1,1,1,1] row_mask:0xf bank_mask:0xf
    v_add_f32_dpp v25, v18, v25 quad_perm:[2,2,2,2] row_mask:0xf bank_mask:0xf
    v_add_f32_dpp v25, v19, v25 quad_perm:[3,3,3,3] row_mask:0xf bank_mask:0xf
    v_mfma_f32_16x16x32_bf16 v[16:19], v[240:243], v[32:35], 0
    v_mfma_f32_16x16x32_bf16 v[16:19], v[244:247], v[36:39], v[16:19]
    v_mfma_f32_16x16x32_bf16 v[16:19], v[248:251], v[40:43], v[16:19]
    v_mfma_f32_16x16x32_bf16 v[16:19], v[252:255], v[44:47], v[16:19]
    s_nop 3
    v_mov_b32_dpp v26, v12 quad_perm:[0,0,0,0] row_mask:0xf bank_mask:0xf
    v_add_f32_dpp v26, v13, v26 quad_perm:[1,1,1,1] row_mask:0xf bank_mask:0xf
    v_add_f32_dpp v26, v14, v26 quad_perm:[2,2,2,2] row_mask:0xf bank_mask:0xf
    v_add_f32_dpp v26, v15, v26 quad_perm:[3,3,3,3] row_mask:0xf bank_mask:0xf
    s_nop 7
    v_mov_b32_dpp v27, v16 quad_perm:[0,0,0,0] row_mask:0xf bank_mask:0xf
    v_add_f32_dpp v27, v17, v27 quad_perm:[1,1,1,1] row_mask:0xf bank_mask:0xf
    v_add_f32_dpp v27, v18, v27 quad_perm:[2,2,2,2] row_mask:0xf bank_mask:0xf
    v_add_f32_dpp v27, v19, v27 quad_perm:[3,3,3,3] row_mask:0xf bank_mask:0xf

    v_max3_f32 v3, v20, v21, v22
    v_max3_f32 v4, v23, v24, v25
    v_max3_f32 v3, v3, v26, v27
    v_max_f32 v3, v3, v4
    s_nop 1
    v_max_f32_dpp v3, v3, v3 row_ror:4 row_mask:0xf bank_mask:0xf
    s_nop 1
    v_max_f32_dpp v3, v3, v3 row_ror:8 row_mask:0xf bank_mask:0xf
    s_nop 1
    v_max_f32_dpp v3, v3, v3 row_bcast:15 row_mask:0xa bank_mask:0xf
    s_nop 1
    v_max_f32_dpp v3, v3, v3 row_bcast:31 row_mask:0xc bank_mask:0xf
    s_nop 1
    v_readlane_b32 s88, v3, 63
    s_nop 1

    v_mov_b32 v62, s88
    v_mul_f32 v62, s86, v62
    v_fma_f32 v20, v20, s86, -v62
    v_fma_f32 v21, v21, s86, -v62
    v_fma_f32 v22, v22, s86, -v62
    v_fma_f32 v23, v23, s86, -v62
    v_fma_f32 v24, v24, s86, -v62
    v_fma_f32 v25, v25, s86, -v62
    v_fma_f32 v26, v26, s86, -v62
    v_fma_f32 v27, v27, s86, -v62
    v_exp_f32 v20, v20
    v_exp_f32 v21, v21
    v_exp_f32 v22, v22
    v_exp_f32 v23, v23
    v_exp_f32 v24, v24
    v_exp_f32 v25, v25
    v_exp_f32 v26, v26
    v_exp_f32 v27, v27

    s_nop 0
    v_add_f32 v3, v20, v21
    v_add_f32 v4, v22, v23
    v_add_f32 v5, v24, v25
    v_add_f32 v63, v26, v27
    v_add_f32 v3, v3, v4
    v_add_f32 v5, v5, v63
    v_add_f32 v3, v3, v5
    v_cvt_pk_bf16_f32 v20, v20, v20
    v_cvt_pk_bf16_f32 v21, v21, v21
    v_cvt_pk_bf16_f32 v22, v22, v22
    v_cvt_pk_bf16_f32 v23, v23, v23
    v_cvt_pk_bf16_f32 v24, v24, v24
    v_cvt_pk_bf16_f32 v25, v25, v25
    v_cvt_pk_bf16_f32 v26, v26, v26
    v_cvt_pk_bf16_f32 v27, v27, v27
    s_nop 1
    v_add_f32_dpp v3, v3, v3 row_ror:4 row_mask:0xf bank_mask:0xf
    s_nop 1
    v_add_f32_dpp v3, v3, v3 row_ror:8 row_mask:0xf bank_mask:0xf
    s_nop 1
    v_add_f32_dpp v3, v3, v3 row_bcast:15 row_mask:0xa bank_mask:0xf
    s_nop 1
    v_add_f32_dpp v3, v3, v3 row_bcast:31 row_mask:0xc bank_mask:0xf
    s_nop 1
    v_readlane_b32 s88, v3, 63
    s_nop 1

    v_mov_b32 v63, s88
    s_lshl_b32 s88, s3, 3
    v_mov_b32 v3, s88
    v_mov_b32 v4, 1
    v_mov_b32 v5, 0
    s_mov_b64 exec, 1
    ds_write_b64 v3, v[62:63] offset:48256
    ds_add_u32 v5, v4 offset:48324
    s_mov_b64 exec, -1
    s_waitcnt vmcnt(11)
    buffer_load_dwordx4 v[128:131], v2, s[12:15], s56 offen offset:0 nt
    v_and_b32_dpp v32, v20, v28 row_newbcast:0 row_mask:0xf bank_mask:0xf
    v_and_b32_dpp v33, v20, v29 row_newbcast:0 row_mask:0xf bank_mask:0xf
    v_and_b32_dpp v34, v20, v30 row_newbcast:0 row_mask:0xf bank_mask:0xf
    v_and_b32_dpp v35, v20, v31 row_newbcast:0 row_mask:0xf bank_mask:0xf
    v_and_b32_dpp v36, v20, v28 row_newbcast:4 row_mask:0xf bank_mask:0xf
    v_and_b32_dpp v37, v20, v29 row_newbcast:4 row_mask:0xf bank_mask:0xf
    v_and_b32_dpp v38, v20, v30 row_newbcast:4 row_mask:0xf bank_mask:0xf
    v_and_b32_dpp v39, v20, v31 row_newbcast:4 row_mask:0xf bank_mask:0xf
    v_mfma_f32_16x16x32_bf16 v[8:11], v[64:67], v[32:35], 0
    s_nop 0
    v_mfma_f32_16x16x32_bf16 v[8:11], v[68:71], v[36:39], v[8:11]
    s_waitcnt vmcnt(11)
    buffer_load_dwordx4 v[132:135], v2, s[12:15], s56 offen offset:1024 nt
    v_and_b32_dpp v32, v20, v28 row_newbcast:8 row_mask:0xf bank_mask:0xf
    v_and_b32_dpp v33, v20, v29 row_newbcast:8 row_mask:0xf bank_mask:0xf
    v_and_b32_dpp v34, v20, v30 row_newbcast:8 row_mask:0xf bank_mask:0xf
    v_and_b32_dpp v35, v20, v31 row_newbcast:8 row_mask:0xf bank_mask:0xf
    v_and_b32_dpp v36, v20, v28 row_newbcast:12 row_mask:0xf bank_mask:0xf
    v_and_b32_dpp v37, v20, v29 row_newbcast:12 row_mask:0xf bank_mask:0xf
    v_and_b32_dpp v38, v20, v30 row_newbcast:12 row_mask:0xf bank_mask:0xf
    v_and_b32_dpp v39, v20, v31 row_newbcast:12 row_mask:0xf bank_mask:0xf
    v_mfma_f32_16x16x32_bf16 v[8:11], v[72:75], v[32:35], v[8:11]
    s_nop 0
    v_mfma_f32_16x16x32_bf16 v[8:11], v[76:79], v[36:39], v[8:11]
    s_waitcnt vmcnt(11)
    buffer_load_dwordx4 v[136:139], v2, s[12:15], s56 offen offset:2048 nt
    v_and_b32_dpp v32, v21, v28 row_newbcast:0 row_mask:0xf bank_mask:0xf
    v_and_b32_dpp v33, v21, v29 row_newbcast:0 row_mask:0xf bank_mask:0xf
    v_and_b32_dpp v34, v21, v30 row_newbcast:0 row_mask:0xf bank_mask:0xf
    v_and_b32_dpp v35, v21, v31 row_newbcast:0 row_mask:0xf bank_mask:0xf
    v_and_b32_dpp v36, v21, v28 row_newbcast:4 row_mask:0xf bank_mask:0xf
    v_and_b32_dpp v37, v21, v29 row_newbcast:4 row_mask:0xf bank_mask:0xf
    v_and_b32_dpp v38, v21, v30 row_newbcast:4 row_mask:0xf bank_mask:0xf
    v_and_b32_dpp v39, v21, v31 row_newbcast:4 row_mask:0xf bank_mask:0xf
    v_mfma_f32_16x16x32_bf16 v[8:11], v[80:83], v[32:35], v[8:11]
    s_nop 0
    v_mfma_f32_16x16x32_bf16 v[8:11], v[84:87], v[36:39], v[8:11]
    s_waitcnt vmcnt(11)
    buffer_load_dwordx4 v[140:143], v2, s[12:15], s56 offen offset:3072 nt
    v_and_b32_dpp v32, v21, v28 row_newbcast:8 row_mask:0xf bank_mask:0xf
    v_and_b32_dpp v33, v21, v29 row_newbcast:8 row_mask:0xf bank_mask:0xf
    v_and_b32_dpp v34, v21, v30 row_newbcast:8 row_mask:0xf bank_mask:0xf
    v_and_b32_dpp v35, v21, v31 row_newbcast:8 row_mask:0xf bank_mask:0xf
    v_and_b32_dpp v36, v21, v28 row_newbcast:12 row_mask:0xf bank_mask:0xf
    v_and_b32_dpp v37, v21, v29 row_newbcast:12 row_mask:0xf bank_mask:0xf
    v_and_b32_dpp v38, v21, v30 row_newbcast:12 row_mask:0xf bank_mask:0xf
    v_and_b32_dpp v39, v21, v31 row_newbcast:12 row_mask:0xf bank_mask:0xf
    v_mfma_f32_16x16x32_bf16 v[8:11], v[88:91], v[32:35], v[8:11]
    s_nop 0
    v_mfma_f32_16x16x32_bf16 v[8:11], v[92:95], v[36:39], v[8:11]
    s_waitcnt vmcnt(11)
    buffer_load_dwordx4 v[144:147], v2, s[12:15], s57 offen offset:0 nt
    v_and_b32_dpp v32, v22, v28 row_newbcast:0 row_mask:0xf bank_mask:0xf
    v_and_b32_dpp v33, v22, v29 row_newbcast:0 row_mask:0xf bank_mask:0xf
    v_and_b32_dpp v34, v22, v30 row_newbcast:0 row_mask:0xf bank_mask:0xf
    v_and_b32_dpp v35, v22, v31 row_newbcast:0 row_mask:0xf bank_mask:0xf
    s_nop 1
    v_mfma_f32_16x16x32_bf16 v[8:11], v[96:99], v[32:35], v[8:11]
    s_waitcnt vmcnt(11)
    buffer_load_dwordx4 v[148:151], v2, s[12:15], s57 offen offset:1024 nt
    v_and_b32_dpp v32, v22, v28 row_newbcast:4 row_mask:0xf bank_mask:0xf
    v_and_b32_dpp v33, v22, v29 row_newbcast:4 row_mask:0xf bank_mask:0xf
    v_and_b32_dpp v34, v22, v30 row_newbcast:4 row_mask:0xf bank_mask:0xf
    v_and_b32_dpp v35, v22, v31 row_newbcast:4 row_mask:0xf bank_mask:0xf
    s_nop 1
    v_mfma_f32_16x16x32_bf16 v[8:11], v[100:103], v[32:35], v[8:11]
    s_waitcnt vmcnt(11)
    buffer_load_dwordx4 v[152:155], v2, s[12:15], s57 offen offset:2048 nt
    v_and_b32_dpp v32, v22, v28 row_newbcast:8 row_mask:0xf bank_mask:0xf
    v_and_b32_dpp v33, v22, v29 row_newbcast:8 row_mask:0xf bank_mask:0xf
    v_and_b32_dpp v34, v22, v30 row_newbcast:8 row_mask:0xf bank_mask:0xf
    v_and_b32_dpp v35, v22, v31 row_newbcast:8 row_mask:0xf bank_mask:0xf
    s_nop 1
    v_mfma_f32_16x16x32_bf16 v[8:11], v[104:107], v[32:35], v[8:11]
    s_waitcnt vmcnt(11)
    buffer_load_dwordx4 v[156:159], v2, s[12:15], s57 offen offset:3072 nt
    v_and_b32_dpp v32, v22, v28 row_newbcast:12 row_mask:0xf bank_mask:0xf
    v_and_b32_dpp v33, v22, v29 row_newbcast:12 row_mask:0xf bank_mask:0xf
    v_and_b32_dpp v34, v22, v30 row_newbcast:12 row_mask:0xf bank_mask:0xf
    v_and_b32_dpp v35, v22, v31 row_newbcast:12 row_mask:0xf bank_mask:0xf
    s_nop 1
    v_mfma_f32_16x16x32_bf16 v[8:11], v[108:111], v[32:35], v[8:11]
    s_waitcnt vmcnt(11)
    s_setprio 0
    buffer_load_dwordx4 v[160:163], v2, s[12:15], s58 offen offset:0 nt
    v_and_b32_dpp v32, v23, v28 row_newbcast:0 row_mask:0xf bank_mask:0xf
    v_and_b32_dpp v33, v23, v29 row_newbcast:0 row_mask:0xf bank_mask:0xf
    v_and_b32_dpp v34, v23, v30 row_newbcast:0 row_mask:0xf bank_mask:0xf
    v_and_b32_dpp v35, v23, v31 row_newbcast:0 row_mask:0xf bank_mask:0xf
    s_nop 1
    v_mfma_f32_16x16x32_bf16 v[8:11], v[112:115], v[32:35], v[8:11]
    s_waitcnt vmcnt(11)
    buffer_load_dwordx4 v[164:167], v2, s[12:15], s58 offen offset:1024 nt
    v_and_b32_dpp v32, v23, v28 row_newbcast:4 row_mask:0xf bank_mask:0xf
    v_and_b32_dpp v33, v23, v29 row_newbcast:4 row_mask:0xf bank_mask:0xf
    v_and_b32_dpp v34, v23, v30 row_newbcast:4 row_mask:0xf bank_mask:0xf
    v_and_b32_dpp v35, v23, v31 row_newbcast:4 row_mask:0xf bank_mask:0xf
    s_nop 1
    v_mfma_f32_16x16x32_bf16 v[8:11], v[116:119], v[32:35], v[8:11]
    s_waitcnt vmcnt(11)
    buffer_load_dwordx4 v[168:171], v2, s[12:15], s58 offen offset:2048 nt
    v_and_b32_dpp v32, v23, v28 row_newbcast:8 row_mask:0xf bank_mask:0xf
    v_and_b32_dpp v33, v23, v29 row_newbcast:8 row_mask:0xf bank_mask:0xf
    v_and_b32_dpp v34, v23, v30 row_newbcast:8 row_mask:0xf bank_mask:0xf
    v_and_b32_dpp v35, v23, v31 row_newbcast:8 row_mask:0xf bank_mask:0xf
    s_nop 1
    v_mfma_f32_16x16x32_bf16 v[8:11], v[120:123], v[32:35], v[8:11]
    s_waitcnt vmcnt(11)
    buffer_load_dwordx4 v[172:175], v2, s[12:15], s58 offen offset:3072 nt
    v_and_b32_dpp v32, v23, v28 row_newbcast:12 row_mask:0xf bank_mask:0xf
    v_and_b32_dpp v33, v23, v29 row_newbcast:12 row_mask:0xf bank_mask:0xf
    v_and_b32_dpp v34, v23, v30 row_newbcast:12 row_mask:0xf bank_mask:0xf
    v_and_b32_dpp v35, v23, v31 row_newbcast:12 row_mask:0xf bank_mask:0xf
    s_nop 1
    v_mfma_f32_16x16x32_bf16 v[8:11], v[124:127], v[32:35], v[8:11]
    s_waitcnt vmcnt(11)
    buffer_load_dwordx4 v[176:179], v2, s[12:15], s59 offen offset:0 nt
    v_and_b32_dpp v32, v24, v28 row_newbcast:0 row_mask:0xf bank_mask:0xf
    v_and_b32_dpp v33, v24, v29 row_newbcast:0 row_mask:0xf bank_mask:0xf
    v_and_b32_dpp v34, v24, v30 row_newbcast:0 row_mask:0xf bank_mask:0xf
    v_and_b32_dpp v35, v24, v31 row_newbcast:0 row_mask:0xf bank_mask:0xf
    s_nop 1
    v_mfma_f32_16x16x32_bf16 v[8:11], v[128:131], v[32:35], v[8:11]
    s_waitcnt vmcnt(11)
    buffer_load_dwordx4 v[180:183], v2, s[12:15], s59 offen offset:1024 nt
    v_and_b32_dpp v32, v24, v28 row_newbcast:4 row_mask:0xf bank_mask:0xf
    v_and_b32_dpp v33, v24, v29 row_newbcast:4 row_mask:0xf bank_mask:0xf
    v_and_b32_dpp v34, v24, v30 row_newbcast:4 row_mask:0xf bank_mask:0xf
    v_and_b32_dpp v35, v24, v31 row_newbcast:4 row_mask:0xf bank_mask:0xf
    s_nop 1
    v_mfma_f32_16x16x32_bf16 v[8:11], v[132:135], v[32:35], v[8:11]
    s_waitcnt vmcnt(11)
    buffer_load_dwordx4 v[184:187], v2, s[12:15], s59 offen offset:2048 nt
    v_and_b32_dpp v32, v24, v28 row_newbcast:8 row_mask:0xf bank_mask:0xf
    v_and_b32_dpp v33, v24, v29 row_newbcast:8 row_mask:0xf bank_mask:0xf
    v_and_b32_dpp v34, v24, v30 row_newbcast:8 row_mask:0xf bank_mask:0xf
    v_and_b32_dpp v35, v24, v31 row_newbcast:8 row_mask:0xf bank_mask:0xf
    s_nop 1
    v_mfma_f32_16x16x32_bf16 v[8:11], v[136:139], v[32:35], v[8:11]
    s_waitcnt vmcnt(11)
    buffer_load_dwordx4 v[188:191], v2, s[12:15], s59 offen offset:3072 nt
    v_and_b32_dpp v32, v24, v28 row_newbcast:12 row_mask:0xf bank_mask:0xf
    v_and_b32_dpp v33, v24, v29 row_newbcast:12 row_mask:0xf bank_mask:0xf
    v_and_b32_dpp v34, v24, v30 row_newbcast:12 row_mask:0xf bank_mask:0xf
    v_and_b32_dpp v35, v24, v31 row_newbcast:12 row_mask:0xf bank_mask:0xf
    s_nop 1
    v_mfma_f32_16x16x32_bf16 v[8:11], v[140:143], v[32:35], v[8:11]
    v_and_b32_dpp v32, v25, v28 row_newbcast:0 row_mask:0xf bank_mask:0xf
    v_and_b32_dpp v33, v25, v29 row_newbcast:0 row_mask:0xf bank_mask:0xf
    v_and_b32_dpp v34, v25, v30 row_newbcast:0 row_mask:0xf bank_mask:0xf
    v_and_b32_dpp v35, v25, v31 row_newbcast:0 row_mask:0xf bank_mask:0xf
    s_waitcnt vmcnt(11)
    s_nop 0
    v_mfma_f32_16x16x32_bf16 v[8:11], v[144:147], v[32:35], v[8:11]
    v_and_b32_dpp v36, v25, v28 row_newbcast:4 row_mask:0xf bank_mask:0xf
    v_and_b32_dpp v37, v25, v29 row_newbcast:4 row_mask:0xf bank_mask:0xf
    v_and_b32_dpp v38, v25, v30 row_newbcast:4 row_mask:0xf bank_mask:0xf
    v_and_b32_dpp v39, v25, v31 row_newbcast:4 row_mask:0xf bank_mask:0xf
    s_waitcnt vmcnt(10)
    s_nop 0
    v_mfma_f32_16x16x32_bf16 v[8:11], v[148:151], v[36:39], v[8:11]
    v_and_b32_dpp v32, v25, v28 row_newbcast:8 row_mask:0xf bank_mask:0xf
    v_and_b32_dpp v33, v25, v29 row_newbcast:8 row_mask:0xf bank_mask:0xf
    v_and_b32_dpp v34, v25, v30 row_newbcast:8 row_mask:0xf bank_mask:0xf
    v_and_b32_dpp v35, v25, v31 row_newbcast:8 row_mask:0xf bank_mask:0xf
    s_waitcnt vmcnt(9)
    s_nop 0
    v_mfma_f32_16x16x32_bf16 v[8:11], v[152:155], v[32:35], v[8:11]
    v_and_b32_dpp v36, v25, v28 row_newbcast:12 row_mask:0xf bank_mask:0xf
    v_and_b32_dpp v37, v25, v29 row_newbcast:12 row_mask:0xf bank_mask:0xf
    v_and_b32_dpp v38, v25, v30 row_newbcast:12 row_mask:0xf bank_mask:0xf
    v_and_b32_dpp v39, v25, v31 row_newbcast:12 row_mask:0xf bank_mask:0xf
    s_waitcnt vmcnt(8)
    s_nop 0
    v_mfma_f32_16x16x32_bf16 v[8:11], v[156:159], v[36:39], v[8:11]
    v_and_b32_dpp v32, v26, v28 row_newbcast:0 row_mask:0xf bank_mask:0xf
    v_and_b32_dpp v33, v26, v29 row_newbcast:0 row_mask:0xf bank_mask:0xf
    v_and_b32_dpp v34, v26, v30 row_newbcast:0 row_mask:0xf bank_mask:0xf
    v_and_b32_dpp v35, v26, v31 row_newbcast:0 row_mask:0xf bank_mask:0xf
    s_waitcnt vmcnt(7)
    s_nop 0
    v_mfma_f32_16x16x32_bf16 v[8:11], v[160:163], v[32:35], v[8:11]
    v_and_b32_dpp v36, v26, v28 row_newbcast:4 row_mask:0xf bank_mask:0xf
    v_and_b32_dpp v37, v26, v29 row_newbcast:4 row_mask:0xf bank_mask:0xf
    v_and_b32_dpp v38, v26, v30 row_newbcast:4 row_mask:0xf bank_mask:0xf
    v_and_b32_dpp v39, v26, v31 row_newbcast:4 row_mask:0xf bank_mask:0xf
    s_waitcnt vmcnt(6)
    s_nop 0
    v_mfma_f32_16x16x32_bf16 v[8:11], v[164:167], v[36:39], v[8:11]
    v_and_b32_dpp v32, v26, v28 row_newbcast:8 row_mask:0xf bank_mask:0xf
    v_and_b32_dpp v33, v26, v29 row_newbcast:8 row_mask:0xf bank_mask:0xf
    v_and_b32_dpp v34, v26, v30 row_newbcast:8 row_mask:0xf bank_mask:0xf
    v_and_b32_dpp v35, v26, v31 row_newbcast:8 row_mask:0xf bank_mask:0xf
    s_waitcnt vmcnt(5)
    s_nop 0
    v_mfma_f32_16x16x32_bf16 v[8:11], v[168:171], v[32:35], v[8:11]
    v_and_b32_dpp v36, v26, v28 row_newbcast:12 row_mask:0xf bank_mask:0xf
    v_and_b32_dpp v37, v26, v29 row_newbcast:12 row_mask:0xf bank_mask:0xf
    v_and_b32_dpp v38, v26, v30 row_newbcast:12 row_mask:0xf bank_mask:0xf
    v_and_b32_dpp v39, v26, v31 row_newbcast:12 row_mask:0xf bank_mask:0xf
    s_waitcnt vmcnt(4)
    s_nop 0
    v_mfma_f32_16x16x32_bf16 v[8:11], v[172:175], v[36:39], v[8:11]
    v_and_b32_dpp v32, v27, v28 row_newbcast:0 row_mask:0xf bank_mask:0xf
    v_and_b32_dpp v33, v27, v29 row_newbcast:0 row_mask:0xf bank_mask:0xf
    v_and_b32_dpp v34, v27, v30 row_newbcast:0 row_mask:0xf bank_mask:0xf
    v_and_b32_dpp v35, v27, v31 row_newbcast:0 row_mask:0xf bank_mask:0xf
    s_waitcnt vmcnt(3)
    s_nop 0
    v_mfma_f32_16x16x32_bf16 v[8:11], v[176:179], v[32:35], v[8:11]
    v_and_b32_dpp v36, v27, v28 row_newbcast:4 row_mask:0xf bank_mask:0xf
    v_and_b32_dpp v37, v27, v29 row_newbcast:4 row_mask:0xf bank_mask:0xf
    v_and_b32_dpp v38, v27, v30 row_newbcast:4 row_mask:0xf bank_mask:0xf
    v_and_b32_dpp v39, v27, v31 row_newbcast:4 row_mask:0xf bank_mask:0xf
    s_waitcnt vmcnt(2)
    s_nop 0
    v_mfma_f32_16x16x32_bf16 v[8:11], v[180:183], v[36:39], v[8:11]
    v_and_b32_dpp v32, v27, v28 row_newbcast:8 row_mask:0xf bank_mask:0xf
    v_and_b32_dpp v33, v27, v29 row_newbcast:8 row_mask:0xf bank_mask:0xf
    v_and_b32_dpp v34, v27, v30 row_newbcast:8 row_mask:0xf bank_mask:0xf
    v_and_b32_dpp v35, v27, v31 row_newbcast:8 row_mask:0xf bank_mask:0xf
    s_waitcnt vmcnt(1)
    s_nop 0
    v_mfma_f32_16x16x32_bf16 v[8:11], v[184:187], v[32:35], v[8:11]
    v_and_b32_dpp v36, v27, v28 row_newbcast:12 row_mask:0xf bank_mask:0xf
    v_and_b32_dpp v37, v27, v29 row_newbcast:12 row_mask:0xf bank_mask:0xf
    v_and_b32_dpp v38, v27, v30 row_newbcast:12 row_mask:0xf bank_mask:0xf
    v_and_b32_dpp v39, v27, v31 row_newbcast:12 row_mask:0xf bank_mask:0xf
    s_waitcnt vmcnt(0)
    s_nop 0
    v_mfma_f32_16x16x32_bf16 v[8:11], v[188:191], v[36:39], v[8:11]

    v_lshrrev_b32 v3, 4, v0
    v_and_b32 v4, 7, v0
    v_lshl_add_u32 v3, v3, 5, v4
    s_lshl_b32 s63, s3, 9
    v_lshl_add_u32 v3, v3, 2, s63
    s_nop 3
    ds_write_b32 v3, v8 offset:43008
    ds_write_b32 v3, v9 offset:43040
    ds_write_b32 v3, v10 offset:43072
    ds_write_b32 v3, v11 offset:43104
    s_waitcnt lgkmcnt(0)
    s_barrier
    buffer_load_dwordx4 v[116:119], v6, s[28:31], 0 offen nt
    buffer_load_dwordx4 v[120:123], v6, s[28:31], s62 offen nt
    buffer_load_dwordx4 v[124:127], v6, s[32:35], 0 offen nt

    s_lshl_b32 s63, s3, 11
    v_add_u32 v3, s63, v2
    s_lshl_b32 s63, s3, 10
    v_add_u32 v4, s63, v2
    s_waitcnt vmcnt(0)

    ds_write_b128 v3, v[116:119] offset:18432
    ds_write_b128 v3, v[120:123] offset:19456
    ds_write_b128 v4, v[124:127] offset:34816
    s_waitcnt lgkmcnt(0)
    s_barrier
    s_endpgm
L_path0:

    s_mov_b32 s88, 0x9e3779b1
    v_mul_lo_u32 v48, v48, s88
    v_add_u32 v48, 0x7f4a7c15, v48
    s_bitcmp1_b32 s5, 0
    s_cbranch_scc1 L0_nopart

    s_mov_b32 s87, 0
L0_part_spin:
    v_mov_b32 v3, 0
    ds_read_b32 v3, v3 offset:48328
    s_add_u32 s87, s87, 1
    s_waitcnt lgkmcnt(0)
    v_readfirstlane_b32 s88, v3
    s_cmp_eq_u32 s88, 8
    s_cbranch_scc1 L0_part_ok
    s_sleep 1
    s_cmp_lt_u32 s87, 0x100000
    s_cbranch_scc1 L0_part_spin
L0_part_ok:
    ds_read_b128 v[64:67], v2 offset:0
    ds_read_b128 v[68:71], v2 offset:1152
    ds_read_b128 v[72:75], v2 offset:2304
    ds_read_b128 v[76:79], v2 offset:3456
    ds_read_b128 v[80:83], v2 offset:4608
    ds_read_b128 v[84:87], v2 offset:5760
    ds_read_b128 v[88:91], v2 offset:6912
    ds_read_b128 v[92:95], v2 offset:8064
    s_waitcnt lgkmcnt(0)
    ds_read_b128 v[96:99], v2 offset:9216
    v_add_f32 v64, v64, v68
    v_add_f32 v72, v72, v76
    v_add_f32 v80, v80, v84
    v_add_f32 v88, v88, v92
    v_add_f32 v65, v65, v69
    v_add_f32 v73, v73, v77
    v_add_f32 v81, v81, v85
    v_add_f32 v89, v89, v93
    v_add_f32 v66, v66, v70
    v_add_f32 v74, v74, v78
    v_add_f32 v82, v82, v86
    v_add_f32 v90, v90, v94
    ds_read_b128 v[100:103], v2 offset:10368
    ds_read_b128 v[104:107], v2 offset:11520
    ds_read_b128 v[108:111], v2 offset:12672
    ds_read_b128 v[112:115], v2 offset:13824
    ds_read_b128 v[116:119], v2 offset:14976
    ds_read_b128 v[120:123], v2 offset:16128
    ds_read_b128 v[124:127], v2 offset:17280
    v_add_f32 v64, v64, v72
    v_add_f32 v80, v80, v88
    v_add_f32 v64, v64, v80
    v_add_f32 v65, v65, v73
    v_add_f32 v81, v81, v89
    v_add_f32 v65, v65, v81
    v_add_f32 v66, v66, v74
    v_add_f32 v82, v82, v90
    v_add_f32 v66, v66, v82

    s_waitcnt lgkmcnt(0)
    s_mov_b32 exec_lo, 0
    s_mov_b32 exec_hi, 0x07fff800
    v_add_f32 v64, v64, v96
    v_add_f32 v64, v64, v100
    v_add_f32 v64, v64, v104
    v_add_f32 v64, v64, v108
    v_add_f32 v64, v64, v112
    v_add_f32 v64, v64, v116
    v_add_f32 v64, v64, v120
    v_add_f32 v64, v64, v124
    v_add_f32 v65, v65, v97
    v_add_f32 v65, v65, v101
    v_add_f32 v65, v65, v105
    v_add_f32 v65, v65, v109
    v_add_f32 v65, v65, v113
    v_add_f32 v65, v65, v117
    v_add_f32 v65, v65, v121
    v_add_f32 v65, v65, v125
    v_add_f32 v66, v66, v98
    v_add_f32 v66, v66, v102
    v_add_f32 v66, v66, v106
    v_add_f32 v66, v66, v110
    v_add_f32 v66, v66, v114
    v_add_f32 v66, v66, v118
    v_add_f32 v66, v66, v122
    v_add_f32 v66, v66, v126
    s_mov_b64 exec, -1
L0_nopart:
    v_mov_b32 v67, v48
    buffer_store_dwordx4 v[64:67], v2, s[36:39], s64 offen sc1
    s_waitcnt vmcnt(11)
    s_setprio 2
    buffer_load_dwordx4 v[64:67], v2, s[12:15], s52 offen offset:0 nt
    buffer_load_dwordx4 v[96:99], v2, s[36:39], s65 offen offset:0 sc1
    buffer_load_dwordx4 v[104:107], v2, s[36:39], s65 offen offset:2048 sc1
    buffer_load_dwordx4 v[112:115], v2, s[36:39], s66 offen offset:0 sc1
    buffer_load_dwordx4 v[120:123], v2, s[36:39], s66 offen offset:2048 sc1
    s_waitcnt vmcnt(11)
    buffer_load_dwordx4 v[68:71], v2, s[12:15], s52 offen offset:1024 nt
    s_waitcnt vmcnt(11)
    buffer_load_dwordx4 v[72:75], v2, s[12:15], s52 offen offset:2048 nt
    s_waitcnt vmcnt(11)
    buffer_load_dwordx4 v[76:79], v2, s[12:15], s52 offen offset:3072 nt
    s_waitcnt vmcnt(11)
    buffer_load_dwordx4 v[80:83], v2, s[12:15], s53 offen offset:0 nt
    s_waitcnt vmcnt(11)
    buffer_load_dwordx4 v[84:87], v2, s[12:15], s53 offen offset:1024 nt
    s_waitcnt vmcnt(11)
    buffer_load_dwordx4 v[88:91], v2, s[12:15], s53 offen offset:2048 nt
    s_waitcnt vmcnt(11)
    s_waitcnt vmcnt(6)
    s_setprio 3
    v_xor_b32 v3, v99, v48
    v_xor_b32 v4, v107, v48
    v_or_b32 v3, v3, v4
    v_xor_b32 v4, v115, v48
    v_or_b32 v3, v3, v4
    v_xor_b32 v4, v123, v48
    v_or_b32 v3, v3, v4
    v_cmp_ne_u32 vcc, 0, v3

    s_cbranch_vccz Lq_ok
    s_mov_b32 s87, 0
Lq_retry:
    buffer_load_dwordx4 v[96:99], v2, s[36:39], s65 offen offset:0 sc1
    buffer_load_dwordx4 v[104:107], v2, s[36:39], s65 offen offset:2048 sc1
    buffer_load_dwordx4 v[112:115], v2, s[36:39], s66 offen offset:0 sc1
    buffer_load_dwordx4 v[120:123], v2, s[36:39], s66 offen offset:2048 sc1
    s_add_u32 s87, s87, 1
    s_waitcnt vmcnt(0)
    v_xor_b32 v3, v99, v48
    v_xor_b32 v4, v107, v48
    v_or_b32 v3, v3, v4
    v_xor_b32 v4, v115, v48
    v_or_b32 v3, v3, v4
    v_xor_b32 v4, v123, v48
    v_or_b32 v3, v3, v4
    v_cmp_ne_u32 vcc, 0, v3

    s_cbranch_vccz Lq_ok
    s_cmp_lt_u32 s87, 0x8000
    s_cbranch_scc1 Lq_retry
Lq_ok:
    v_add_f32 v96, v96, v104
    v_add_f32 v112, v112, v120
    v_add_f32 v96, v96, v112
    v_add_f32 v97, v97, v105
    v_add_f32 v113, v113, v121
    v_add_f32 v97, v97, v113
    v_add_f32 v98, v98, v106
    v_add_f32 v114, v114, v122
    v_add_f32 v98, v98, v114

    v_cvt_pk_bf16_f32 v100, v96, v97
    v_cvt_pk_bf16_f32 v101, v98, v98
    v_mul_u32_u24 v3, 6, v0
    v_subrev_u32 v4, 43, v0
    v_mul_u32_u24 v4, 12, v4
    s_mov_b32 exec_lo, -1
    s_mov_b32 exec_hi, 0x7ff
    ds_write_b16 v3, v100 offset:47104
    ds_write_b16_d16_hi v3, v100 offset:47106
    ds_write_b16 v3, v101 offset:47108
    s_mov_b32 exec_lo, 0
    s_mov_b32 exec_hi, 0x07fff800
    ds_write_b32 v4, v96 offset:47616
    ds_write_b32 v4, v97 offset:47620
    ds_write_b32 v4, v98 offset:47624
    s_mov_b64 exec, 1
    v_mov_b32 v3, 0
    v_mov_b32 v4, 1
    ds_write_b32 v3, v4 offset:48320
    s_mov_b64 exec, -1
    v_lshlrev_b32 v3, 2, v0
    ds_read_b32 v96, v3 offset:47616
    v_lshlrev_b32 v49, 16, v49
    s_lshl_b32 s88, s6, 3
    s_waitcnt lgkmcnt(0)
    v_cvt_pk_bf16_f32 v96, v96, v96
    v_and_b32 v96, 0xffff0000, v96
    v_add_f32 v96, v96, v49
    v_cvt_pk_bf16_f32 v96, v96, v96
    v_and_b32 v96, 0xffff0000, v96

    v_mul_f32 v97, v96, v96
    v_mov_b32 v98, 0xc0135761
    v_fmac_f32 v98, 0xbdd2d3e8, v97
    v_mul_f32 v98, v98, v96
    v_exp_f32 v98, v98
    s_nop 0
    v_add_f32 v98, 1.0, v98
    v_rcp_f32 v98, v98
    v_cmp_gt_u32 vcc, s88, v0
    v_mul_f32 v96, v96, v98
    v_lshlrev_b32 v3, 1, v0
    v_cvt_pk_bf16_f32 v96, v96, v96
    v_cndmask_b32 v96, 0, v96, vcc
    ds_write_b16 v3, v96 offset:47872
    s_setprio 2
    buffer_load_dwordx4 v[92:95], v2, s[12:15], s53 offen offset:3072 nt
    s_waitcnt vmcnt(11)
    buffer_load_dwordx4 v[96:99], v2, s[12:15], s54 offen offset:0 nt
    s_waitcnt vmcnt(11)
    buffer_load_dwordx4 v[100:103], v2, s[12:15], s54 offen offset:1024 nt
    s_waitcnt vmcnt(11)
    buffer_load_dwordx4 v[104:107], v2, s[12:15], s54 offen offset:2048 nt
    s_waitcnt vmcnt(11)
    buffer_load_dwordx4 v[108:111], v2, s[12:15], s54 offen offset:3072 nt
    s_waitcnt vmcnt(11)
    s_setprio 1
    buffer_load_dwordx4 v[112:115], v2, s[12:15], s55 offen offset:0 nt
    s_waitcnt vmcnt(11)
    buffer_load_dwordx4 v[116:119], v2, s[12:15], s55 offen offset:1024 nt
    s_waitcnt vmcnt(11)
    buffer_load_dwordx4 v[120:123], v2, s[12:15], s55 offen offset:2048 nt
    s_waitcnt vmcnt(11)
    buffer_load_dwordx4 v[124:127], v2, s[12:15], s55 offen offset:3072 nt
    s_waitcnt vmcnt(21)

    v_lshrrev_b32 v3, 4, v0
    v_lshlrev_b32 v3, 6, v3
    v_and_b32 v4, 3, v0
    v_lshl_add_u32 v3, v4, 4, v3
    ds_read_b128 v[12:15], v3 offset:47104
    s_waitcnt lgkmcnt(0)
    v_cndmask_b32_e64 v32, 0, v12, s[72:73]
    v_cndmask_b32_e64 v33, 0, v13, s[72:73]
    v_cndmask_b32_e64 v34, 0, v14, s[72:73]
    v_cndmask_b32_e64 v35, 0, v15, s[72:73]
    v_cndmask_b32_e64 v36, 0, v12, s[74:75]
    v_cndmask_b32_e64 v37, 0, v13, s[74:75]
    v_cndmask_b32_e64 v38, 0, v14, s[74:75]
    v_cndmask_b32_e64 v39, 0, v15, s[74:75]
    v_cndmask_b32_e64 v40, 0, v12, s[76:77]
    v_cndmask_b32_e64 v41, 0, v13, s[76:77]
    v_cndmask_b32_e64 v42, 0, v14, s[76:77]
    v_cndmask_b32_e64 v43, 0, v15, s[76:77]
    v_cndmask_b32_e64 v44, 0, v12, s[78:79]
    v_cndmask_b32_e64 v45, 0, v13, s[78:79]
    v_cndmask_b32_e64 v46, 0, v14, s[78:79]
    v_cndmask_b32_e64 v47, 0, v15, s[78:79]
    s_nop 1
    v_mfma_f32_16x16x32_bf16 v[12:15], v[128:131], v[32:35], 0
    v_mfma_f32_16x16x32_bf16 v[12:15], v[132:135], v[36:39], v[12:15]
    v_mfma_f32_16x16x32_bf16 v[12:15], v[136:139], v[40:43], v[12:15]
    v_mfma_f32_16x16x32_bf16 v[12:15], v[140:143], v[44:47], v[12:15]
    v_mfma_f32_16x16x32_bf16 v[16:19], v[144:147], v[32:35], 0
    v_mfma_f32_16x16x32_bf16 v[16:19], v[148:151], v[36:39], v[16:19]
    v_mfma_f32_16x16x32_bf16 v[16:19], v[152:155], v[40:43], v[16:19]
    v_mfma_f32_16x16x32_bf16 v[16:19], v[156:159], v[44:47], v[16:19]
    s_nop 3
    v_mov_b32_dpp v20, v12 quad_perm:[0,0,0,0] row_mask:0xf bank_mask:0xf
    v_add_f32_dpp v20, v13, v20 quad_perm:[1,1,1,1] row_mask:0xf bank_mask:0xf
    v_add_f32_dpp v20, v14, v20 quad_perm:[2,2,2,2] row_mask:0xf bank_mask:0xf
    v_add_f32_dpp v20, v15, v20 quad_perm:[3,3,3,3] row_mask:0xf bank_mask:0xf
    v_mfma_f32_16x16x32_bf16 v[12:15], v[160:163], v[32:35], 0
    v_mfma_f32_16x16x32_bf16 v[12:15], v[164:167], v[36:39], v[12:15]
    v_mfma_f32_16x16x32_bf16 v[12:15], v[168:171], v[40:43], v[12:15]
    v_mfma_f32_16x16x32_bf16 v[12:15], v[172:175], v[44:47], v[12:15]
    s_nop 3
    v_mov_b32_dpp v21, v16 quad_perm:[0,0,0,0] row_mask:0xf bank_mask:0xf
    v_add_f32_dpp v21, v17, v21 quad_perm:[1,1,1,1] row_mask:0xf bank_mask:0xf
    v_add_f32_dpp v21, v18, v21 quad_perm:[2,2,2,2] row_mask:0xf bank_mask:0xf
    v_add_f32_dpp v21, v19, v21 quad_perm:[3,3,3,3] row_mask:0xf bank_mask:0xf
    v_mfma_f32_16x16x32_bf16 v[16:19], v[176:179], v[32:35], 0
    v_mfma_f32_16x16x32_bf16 v[16:19], v[180:183], v[36:39], v[16:19]
    v_mfma_f32_16x16x32_bf16 v[16:19], v[184:187], v[40:43], v[16:19]
    v_mfma_f32_16x16x32_bf16 v[16:19], v[188:191], v[44:47], v[16:19]
    s_nop 3
    v_mov_b32_dpp v22, v12 quad_perm:[0,0,0,0] row_mask:0xf bank_mask:0xf
    v_add_f32_dpp v22, v13, v22 quad_perm:[1,1,1,1] row_mask:0xf bank_mask:0xf
    v_add_f32_dpp v22, v14, v22 quad_perm:[2,2,2,2] row_mask:0xf bank_mask:0xf
    v_add_f32_dpp v22, v15, v22 quad_perm:[3,3,3,3] row_mask:0xf bank_mask:0xf
    v_mfma_f32_16x16x32_bf16 v[12:15], v[192:195], v[32:35], 0
    v_mfma_f32_16x16x32_bf16 v[12:15], v[196:199], v[36:39], v[12:15]
    v_mfma_f32_16x16x32_bf16 v[12:15], v[200:203], v[40:43], v[12:15]
    v_mfma_f32_16x16x32_bf16 v[12:15], v[204:207], v[44:47], v[12:15]
    s_nop 3
    v_mov_b32_dpp v23, v16 quad_perm:[0,0,0,0] row_mask:0xf bank_mask:0xf
    v_add_f32_dpp v23, v17, v23 quad_perm:[1,1,1,1] row_mask:0xf bank_mask:0xf
    v_add_f32_dpp v23, v18, v23 quad_perm:[2,2,2,2] row_mask:0xf bank_mask:0xf
    v_add_f32_dpp v23, v19, v23 quad_perm:[3,3,3,3] row_mask:0xf bank_mask:0xf
    v_mfma_f32_16x16x32_bf16 v[16:19], v[208:211], v[32:35], 0
    v_mfma_f32_16x16x32_bf16 v[16:19], v[212:215], v[36:39], v[16:19]
    v_mfma_f32_16x16x32_bf16 v[16:19], v[216:219], v[40:43], v[16:19]
    v_mfma_f32_16x16x32_bf16 v[16:19], v[220:223], v[44:47], v[16:19]
    s_nop 3
    v_mov_b32_dpp v24, v12 quad_perm:[0,0,0,0] row_mask:0xf bank_mask:0xf
    v_add_f32_dpp v24, v13, v24 quad_perm:[1,1,1,1] row_mask:0xf bank_mask:0xf
    v_add_f32_dpp v24, v14, v24 quad_perm:[2,2,2,2] row_mask:0xf bank_mask:0xf
    v_add_f32_dpp v24, v15, v24 quad_perm:[3,3,3,3] row_mask:0xf bank_mask:0xf
    v_mfma_f32_16x16x32_bf16 v[12:15], v[224:227], v[32:35], 0
    v_mfma_f32_16x16x32_bf16 v[12:15], v[228:231], v[36:39], v[12:15]
    v_mfma_f32_16x16x32_bf16 v[12:15], v[232:235], v[40:43], v[12:15]
    v_mfma_f32_16x16x32_bf16 v[12:15], v[236:239], v[44:47], v[12:15]
    s_nop 3
    v_mov_b32_dpp v25, v16 quad_perm:[0,0,0,0] row_mask:0xf bank_mask:0xf
    v_add_f32_dpp v25, v17, v25 quad_perm:[1,1,1,1] row_mask:0xf bank_mask:0xf
    v_add_f32_dpp v25, v18, v25 quad_perm:[2,2,2,2] row_mask:0xf bank_mask:0xf
    v_add_f32_dpp v25, v19, v25 quad_perm:[3,3,3,3] row_mask:0xf bank_mask:0xf
    v_mfma_f32_16x16x32_bf16 v[16:19], v[240:243], v[32:35], 0
    v_mfma_f32_16x16x32_bf16 v[16:19], v[244:247], v[36:39], v[16:19]
    v_mfma_f32_16x16x32_bf16 v[16:19], v[248:251], v[40:43], v[16:19]
    v_mfma_f32_16x16x32_bf16 v[16:19], v[252:255], v[44:47], v[16:19]
    s_nop 3
    v_mov_b32_dpp v26, v12 quad_perm:[0,0,0,0] row_mask:0xf bank_mask:0xf
    v_add_f32_dpp v26, v13, v26 quad_perm:[1,1,1,1] row_mask:0xf bank_mask:0xf
    v_add_f32_dpp v26, v14, v26 quad_perm:[2,2,2,2] row_mask:0xf bank_mask:0xf
    v_add_f32_dpp v26, v15, v26 quad_perm:[3,3,3,3] row_mask:0xf bank_mask:0xf
    s_nop 7
    v_mov_b32_dpp v27, v16 quad_perm:[0,0,0,0] row_mask:0xf bank_mask:0xf
    v_add_f32_dpp v27, v17, v27 quad_perm:[1,1,1,1] row_mask:0xf bank_mask:0xf
    v_add_f32_dpp v27, v18, v27 quad_perm:[2,2,2,2] row_mask:0xf bank_mask:0xf
    v_add_f32_dpp v27, v19, v27 quad_perm:[3,3,3,3] row_mask:0xf bank_mask:0xf

    v_max3_f32 v3, v20, v21, v22
    v_max3_f32 v4, v23, v24, v25
    v_max3_f32 v3, v3, v26, v27
    v_max_f32 v3, v3, v4
    s_nop 1
    v_max_f32_dpp v3, v3, v3 row_ror:4 row_mask:0xf bank_mask:0xf
    s_nop 1
    v_max_f32_dpp v3, v3, v3 row_ror:8 row_mask:0xf bank_mask:0xf
    s_nop 1
    v_max_f32_dpp v3, v3, v3 row_bcast:15 row_mask:0xa bank_mask:0xf
    s_nop 1
    v_max_f32_dpp v3, v3, v3 row_bcast:31 row_mask:0xc bank_mask:0xf
    s_nop 1
    v_readlane_b32 s88, v3, 63
    s_nop 1

    v_mov_b32 v62, s88
    v_mul_f32 v62, s86, v62
    v_fma_f32 v20, v20, s86, -v62
    v_fma_f32 v21, v21, s86, -v62
    v_fma_f32 v22, v22, s86, -v62
    v_fma_f32 v23, v23, s86, -v62
    v_fma_f32 v24, v24, s86, -v62
    v_fma_f32 v25, v25, s86, -v62
    v_fma_f32 v26, v26, s86, -v62
    v_fma_f32 v27, v27, s86, -v62
    v_exp_f32 v20, v20
    v_exp_f32 v21, v21
    v_exp_f32 v22, v22
    v_exp_f32 v23, v23
    v_exp_f32 v24, v24
    v_exp_f32 v25, v25
    v_exp_f32 v26, v26
    v_exp_f32 v27, v27

    s_nop 0
    v_add_f32 v3, v20, v21
    v_add_f32 v4, v22, v23
    v_add_f32 v5, v24, v25
    v_add_f32 v63, v26, v27
    v_add_f32 v3, v3, v4
    v_add_f32 v5, v5, v63
    v_add_f32 v3, v3, v5
    v_cvt_pk_bf16_f32 v20, v20, v20
    v_cvt_pk_bf16_f32 v21, v21, v21
    v_cvt_pk_bf16_f32 v22, v22, v22
    v_cvt_pk_bf16_f32 v23, v23, v23
    v_cvt_pk_bf16_f32 v24, v24, v24
    v_cvt_pk_bf16_f32 v25, v25, v25
    v_cvt_pk_bf16_f32 v26, v26, v26
    v_cvt_pk_bf16_f32 v27, v27, v27
    s_nop 1
    v_add_f32_dpp v3, v3, v3 row_ror:4 row_mask:0xf bank_mask:0xf
    s_nop 1
    v_add_f32_dpp v3, v3, v3 row_ror:8 row_mask:0xf bank_mask:0xf
    s_nop 1
    v_add_f32_dpp v3, v3, v3 row_bcast:15 row_mask:0xa bank_mask:0xf
    s_nop 1
    v_add_f32_dpp v3, v3, v3 row_bcast:31 row_mask:0xc bank_mask:0xf
    s_nop 1
    v_readlane_b32 s88, v3, 63
    s_nop 1

    v_mov_b32 v63, s88
    s_lshl_b32 s88, s3, 3
    v_mov_b32 v3, s88
    v_mov_b32 v4, 1
    v_mov_b32 v5, 0
    s_mov_b64 exec, 1
    ds_write_b64 v3, v[62:63] offset:48256
    ds_add_u32 v5, v4 offset:48324
    s_mov_b64 exec, -1
    s_waitcnt vmcnt(11)
    buffer_load_dwordx4 v[128:131], v2, s[12:15], s56 offen offset:0 nt
    v_and_b32_dpp v32, v20, v28 row_newbcast:0 row_mask:0xf bank_mask:0xf
    v_and_b32_dpp v33, v20, v29 row_newbcast:0 row_mask:0xf bank_mask:0xf
    v_and_b32_dpp v34, v20, v30 row_newbcast:0 row_mask:0xf bank_mask:0xf
    v_and_b32_dpp v35, v20, v31 row_newbcast:0 row_mask:0xf bank_mask:0xf
    v_and_b32_dpp v36, v20, v28 row_newbcast:4 row_mask:0xf bank_mask:0xf
    v_and_b32_dpp v37, v20, v29 row_newbcast:4 row_mask:0xf bank_mask:0xf
    v_and_b32_dpp v38, v20, v30 row_newbcast:4 row_mask:0xf bank_mask:0xf
    v_and_b32_dpp v39, v20, v31 row_newbcast:4 row_mask:0xf bank_mask:0xf
    v_mfma_f32_16x16x32_bf16 v[8:11], v[64:67], v[32:35], 0
    s_nop 0
    v_mfma_f32_16x16x32_bf16 v[8:11], v[68:71], v[36:39], v[8:11]
    s_waitcnt vmcnt(11)
    buffer_load_dwordx4 v[132:135], v2, s[12:15], s56 offen offset:1024 nt
    v_and_b32_dpp v32, v20, v28 row_newbcast:8 row_mask:0xf bank_mask:0xf
    v_and_b32_dpp v33, v20, v29 row_newbcast:8 row_mask:0xf bank_mask:0xf
    v_and_b32_dpp v34, v20, v30 row_newbcast:8 row_mask:0xf bank_mask:0xf
    v_and_b32_dpp v35, v20, v31 row_newbcast:8 row_mask:0xf bank_mask:0xf
    v_and_b32_dpp v36, v20, v28 row_newbcast:12 row_mask:0xf bank_mask:0xf
    v_and_b32_dpp v37, v20, v29 row_newbcast:12 row_mask:0xf bank_mask:0xf
    v_and_b32_dpp v38, v20, v30 row_newbcast:12 row_mask:0xf bank_mask:0xf
    v_and_b32_dpp v39, v20, v31 row_newbcast:12 row_mask:0xf bank_mask:0xf
    v_mfma_f32_16x16x32_bf16 v[8:11], v[72:75], v[32:35], v[8:11]
    s_nop 0
    v_mfma_f32_16x16x32_bf16 v[8:11], v[76:79], v[36:39], v[8:11]
    s_waitcnt vmcnt(11)
    buffer_load_dwordx4 v[136:139], v2, s[12:15], s56 offen offset:2048 nt
    v_and_b32_dpp v32, v21, v28 row_newbcast:0 row_mask:0xf bank_mask:0xf
    v_and_b32_dpp v33, v21, v29 row_newbcast:0 row_mask:0xf bank_mask:0xf
    v_and_b32_dpp v34, v21, v30 row_newbcast:0 row_mask:0xf bank_mask:0xf
    v_and_b32_dpp v35, v21, v31 row_newbcast:0 row_mask:0xf bank_mask:0xf
    v_and_b32_dpp v36, v21, v28 row_newbcast:4 row_mask:0xf bank_mask:0xf
    v_and_b32_dpp v37, v21, v29 row_newbcast:4 row_mask:0xf bank_mask:0xf
    v_and_b32_dpp v38, v21, v30 row_newbcast:4 row_mask:0xf bank_mask:0xf
    v_and_b32_dpp v39, v21, v31 row_newbcast:4 row_mask:0xf bank_mask:0xf
    v_mfma_f32_16x16x32_bf16 v[8:11], v[80:83], v[32:35], v[8:11]
    s_nop 0
    v_mfma_f32_16x16x32_bf16 v[8:11], v[84:87], v[36:39], v[8:11]
    s_waitcnt vmcnt(11)
    buffer_load_dwordx4 v[140:143], v2, s[12:15], s56 offen offset:3072 nt
    v_and_b32_dpp v32, v21, v28 row_newbcast:8 row_mask:0xf bank_mask:0xf
    v_and_b32_dpp v33, v21, v29 row_newbcast:8 row_mask:0xf bank_mask:0xf
    v_and_b32_dpp v34, v21, v30 row_newbcast:8 row_mask:0xf bank_mask:0xf
    v_and_b32_dpp v35, v21, v31 row_newbcast:8 row_mask:0xf bank_mask:0xf
    v_and_b32_dpp v36, v21, v28 row_newbcast:12 row_mask:0xf bank_mask:0xf
    v_and_b32_dpp v37, v21, v29 row_newbcast:12 row_mask:0xf bank_mask:0xf
    v_and_b32_dpp v38, v21, v30 row_newbcast:12 row_mask:0xf bank_mask:0xf
    v_and_b32_dpp v39, v21, v31 row_newbcast:12 row_mask:0xf bank_mask:0xf
    v_mfma_f32_16x16x32_bf16 v[8:11], v[88:91], v[32:35], v[8:11]
    s_nop 0
    v_mfma_f32_16x16x32_bf16 v[8:11], v[92:95], v[36:39], v[8:11]
    s_waitcnt vmcnt(11)
    buffer_load_dwordx4 v[144:147], v2, s[12:15], s57 offen offset:0 nt
    v_and_b32_dpp v32, v22, v28 row_newbcast:0 row_mask:0xf bank_mask:0xf
    v_and_b32_dpp v33, v22, v29 row_newbcast:0 row_mask:0xf bank_mask:0xf
    v_and_b32_dpp v34, v22, v30 row_newbcast:0 row_mask:0xf bank_mask:0xf
    v_and_b32_dpp v35, v22, v31 row_newbcast:0 row_mask:0xf bank_mask:0xf
    s_nop 1
    v_mfma_f32_16x16x32_bf16 v[8:11], v[96:99], v[32:35], v[8:11]
    s_waitcnt vmcnt(11)
    buffer_load_dwordx4 v[148:151], v2, s[12:15], s57 offen offset:1024 nt
    v_and_b32_dpp v32, v22, v28 row_newbcast:4 row_mask:0xf bank_mask:0xf
    v_and_b32_dpp v33, v22, v29 row_newbcast:4 row_mask:0xf bank_mask:0xf
    v_and_b32_dpp v34, v22, v30 row_newbcast:4 row_mask:0xf bank_mask:0xf
    v_and_b32_dpp v35, v22, v31 row_newbcast:4 row_mask:0xf bank_mask:0xf
    s_nop 1
    v_mfma_f32_16x16x32_bf16 v[8:11], v[100:103], v[32:35], v[8:11]
    s_waitcnt vmcnt(11)
    buffer_load_dwordx4 v[152:155], v2, s[12:15], s57 offen offset:2048 nt
    v_and_b32_dpp v32, v22, v28 row_newbcast:8 row_mask:0xf bank_mask:0xf
    v_and_b32_dpp v33, v22, v29 row_newbcast:8 row_mask:0xf bank_mask:0xf
    v_and_b32_dpp v34, v22, v30 row_newbcast:8 row_mask:0xf bank_mask:0xf
    v_and_b32_dpp v35, v22, v31 row_newbcast:8 row_mask:0xf bank_mask:0xf
    s_nop 1
    v_mfma_f32_16x16x32_bf16 v[8:11], v[104:107], v[32:35], v[8:11]
    s_waitcnt vmcnt(11)
    buffer_load_dwordx4 v[156:159], v2, s[12:15], s57 offen offset:3072 nt
    v_and_b32_dpp v32, v22, v28 row_newbcast:12 row_mask:0xf bank_mask:0xf
    v_and_b32_dpp v33, v22, v29 row_newbcast:12 row_mask:0xf bank_mask:0xf
    v_and_b32_dpp v34, v22, v30 row_newbcast:12 row_mask:0xf bank_mask:0xf
    v_and_b32_dpp v35, v22, v31 row_newbcast:12 row_mask:0xf bank_mask:0xf
    s_nop 1
    v_mfma_f32_16x16x32_bf16 v[8:11], v[108:111], v[32:35], v[8:11]
    s_waitcnt vmcnt(11)
    s_setprio 0
    buffer_load_dwordx4 v[160:163], v2, s[12:15], s58 offen offset:0 nt
    v_and_b32_dpp v32, v23, v28 row_newbcast:0 row_mask:0xf bank_mask:0xf
    v_and_b32_dpp v33, v23, v29 row_newbcast:0 row_mask:0xf bank_mask:0xf
    v_and_b32_dpp v34, v23, v30 row_newbcast:0 row_mask:0xf bank_mask:0xf
    v_and_b32_dpp v35, v23, v31 row_newbcast:0 row_mask:0xf bank_mask:0xf
    s_nop 1
    v_mfma_f32_16x16x32_bf16 v[8:11], v[112:115], v[32:35], v[8:11]
    s_waitcnt vmcnt(11)
    buffer_load_dwordx4 v[164:167], v2, s[12:15], s58 offen offset:1024 nt
    v_and_b32_dpp v32, v23, v28 row_newbcast:4 row_mask:0xf bank_mask:0xf
    v_and_b32_dpp v33, v23, v29 row_newbcast:4 row_mask:0xf bank_mask:0xf
    v_and_b32_dpp v34, v23, v30 row_newbcast:4 row_mask:0xf bank_mask:0xf
    v_and_b32_dpp v35, v23, v31 row_newbcast:4 row_mask:0xf bank_mask:0xf
    s_nop 1
    v_mfma_f32_16x16x32_bf16 v[8:11], v[116:119], v[32:35], v[8:11]
    s_waitcnt vmcnt(11)
    buffer_load_dwordx4 v[168:171], v2, s[12:15], s58 offen offset:2048 nt
    v_and_b32_dpp v32, v23, v28 row_newbcast:8 row_mask:0xf bank_mask:0xf
    v_and_b32_dpp v33, v23, v29 row_newbcast:8 row_mask:0xf bank_mask:0xf
    v_and_b32_dpp v34, v23, v30 row_newbcast:8 row_mask:0xf bank_mask:0xf
    v_and_b32_dpp v35, v23, v31 row_newbcast:8 row_mask:0xf bank_mask:0xf
    s_nop 1
    v_mfma_f32_16x16x32_bf16 v[8:11], v[120:123], v[32:35], v[8:11]
    s_waitcnt vmcnt(11)
    buffer_load_dwordx4 v[172:175], v2, s[12:15], s58 offen offset:3072 nt
    v_and_b32_dpp v32, v23, v28 row_newbcast:12 row_mask:0xf bank_mask:0xf
    v_and_b32_dpp v33, v23, v29 row_newbcast:12 row_mask:0xf bank_mask:0xf
    v_and_b32_dpp v34, v23, v30 row_newbcast:12 row_mask:0xf bank_mask:0xf
    v_and_b32_dpp v35, v23, v31 row_newbcast:12 row_mask:0xf bank_mask:0xf
    s_nop 1
    v_mfma_f32_16x16x32_bf16 v[8:11], v[124:127], v[32:35], v[8:11]
    s_waitcnt vmcnt(11)
    buffer_load_dwordx4 v[176:179], v2, s[12:15], s59 offen offset:0 nt
    v_and_b32_dpp v32, v24, v28 row_newbcast:0 row_mask:0xf bank_mask:0xf
    v_and_b32_dpp v33, v24, v29 row_newbcast:0 row_mask:0xf bank_mask:0xf
    v_and_b32_dpp v34, v24, v30 row_newbcast:0 row_mask:0xf bank_mask:0xf
    v_and_b32_dpp v35, v24, v31 row_newbcast:0 row_mask:0xf bank_mask:0xf
    s_nop 1
    v_mfma_f32_16x16x32_bf16 v[8:11], v[128:131], v[32:35], v[8:11]
    s_waitcnt vmcnt(11)
    buffer_load_dwordx4 v[180:183], v2, s[12:15], s59 offen offset:1024 nt
    v_and_b32_dpp v32, v24, v28 row_newbcast:4 row_mask:0xf bank_mask:0xf
    v_and_b32_dpp v33, v24, v29 row_newbcast:4 row_mask:0xf bank_mask:0xf
    v_and_b32_dpp v34, v24, v30 row_newbcast:4 row_mask:0xf bank_mask:0xf
    v_and_b32_dpp v35, v24, v31 row_newbcast:4 row_mask:0xf bank_mask:0xf
    s_nop 1
    v_mfma_f32_16x16x32_bf16 v[8:11], v[132:135], v[32:35], v[8:11]
    s_waitcnt vmcnt(11)
    buffer_load_dwordx4 v[184:187], v2, s[12:15], s59 offen offset:2048 nt
    v_and_b32_dpp v32, v24, v28 row_newbcast:8 row_mask:0xf bank_mask:0xf
    v_and_b32_dpp v33, v24, v29 row_newbcast:8 row_mask:0xf bank_mask:0xf
    v_and_b32_dpp v34, v24, v30 row_newbcast:8 row_mask:0xf bank_mask:0xf
    v_and_b32_dpp v35, v24, v31 row_newbcast:8 row_mask:0xf bank_mask:0xf
    s_nop 1
    v_mfma_f32_16x16x32_bf16 v[8:11], v[136:139], v[32:35], v[8:11]
    s_waitcnt vmcnt(11)
    buffer_load_dwordx4 v[188:191], v2, s[12:15], s59 offen offset:3072 nt
    v_and_b32_dpp v32, v24, v28 row_newbcast:12 row_mask:0xf bank_mask:0xf
    v_and_b32_dpp v33, v24, v29 row_newbcast:12 row_mask:0xf bank_mask:0xf
    v_and_b32_dpp v34, v24, v30 row_newbcast:12 row_mask:0xf bank_mask:0xf
    v_and_b32_dpp v35, v24, v31 row_newbcast:12 row_mask:0xf bank_mask:0xf
    s_nop 1
    v_mfma_f32_16x16x32_bf16 v[8:11], v[140:143], v[32:35], v[8:11]

    s_mov_b32 s87, 0
L0_cnt_spin:
    v_mov_b32 v3, 0
    ds_read_b32 v3, v3 offset:48324
    s_add_u32 s87, s87, 1
    s_waitcnt lgkmcnt(0)
    v_readfirstlane_b32 s88, v3
    s_cmp_eq_u32 s88, 8
    s_cbranch_scc1 L0_cnt_ok
    s_sleep 1
    s_cmp_lt_u32 s87, 0x100000
    s_cbranch_scc1 L0_cnt_spin
L0_cnt_ok:
    v_mov_b32 v3, 0
    ds_read_b128 v[12:15], v3 offset:48256
    ds_read_b128 v[16:19], v3 offset:48272
    ds_read_b128 v[40:43], v3 offset:48288
    ds_read_b128 v[44:47], v3 offset:48304
    s_waitcnt lgkmcnt(0)
    v_max3_f32 v3, v12, v14, v16
    v_max3_f32 v4, v18, v40, v42
    v_max3_f32 v3, v3, v44, v46
    v_max_f32 v3, v3, v4
    v_sub_f32 v52, v12, v3
    v_sub_f32 v53, v14, v3
    v_sub_f32 v54, v16, v3
    v_sub_f32 v55, v18, v3
    v_sub_f32 v56, v40, v3
    v_sub_f32 v57, v42, v3
    v_sub_f32 v58, v44, v3
    v_sub_f32 v59, v46, v3
    v_exp_f32 v52, v52
    v_exp_f32 v53, v53
    v_exp_f32 v54, v54
    v_exp_f32 v55, v55
    v_exp_f32 v56, v56
    v_exp_f32 v57, v57
    v_exp_f32 v58, v58
    v_exp_f32 v59, v59
    s_nop 0
    v_mul_f32 v4, v52, v13
    v_fmac_f32 v4, v53, v15
    v_fmac_f32 v4, v54, v17
    v_fmac_f32 v4, v55, v19
    v_fmac_f32 v4, v56, v41
    v_fmac_f32 v4, v57, v43
    v_fmac_f32 v4, v58, v45
    v_fmac_f32 v4, v59, v47
    v_log_f32 v60, v4
    v_rcp_f32 v4, v4
    s_nop 0
    v_add_f32 v60, v60, v3
    v_mul_f32 v52, v52, v4
    v_mul_f32 v53, v53, v4
    v_mul_f32 v54, v54, v4
    v_mul_f32 v55, v55, v4
    v_mul_f32 v56, v56, v4
    v_mul_f32 v57, v57, v4
    v_mul_f32 v58, v58, v4
    v_mul_f32 v59, v59, v4
    v_and_b32_dpp v32, v25, v28 row_newbcast:0 row_mask:0xf bank_mask:0xf
    v_and_b32_dpp v33, v25, v29 row_newbcast:0 row_mask:0xf bank_mask:0xf
    v_and_b32_dpp v34, v25, v30 row_newbcast:0 row_mask:0xf bank_mask:0xf
    v_and_b32_dpp v35, v25, v31 row_newbcast:0 row_mask:0xf bank_mask:0xf
    s_waitcnt vmcnt(11)
    s_nop 0
    v_mfma_f32_16x16x32_bf16 v[8:11], v[144:147], v[32:35], v[8:11]
    v_and_b32_dpp v36, v25, v28 row_newbcast:4 row_mask:0xf bank_mask:0xf
    v_and_b32_dpp v37, v25, v29 row_newbcast:4 row_mask:0xf bank_mask:0xf
    v_and_b32_dpp v38, v25, v30 row_newbcast:4 row_mask:0xf bank_mask:0xf
    v_and_b32_dpp v39, v25, v31 row_newbcast:4 row_mask:0xf bank_mask:0xf
    s_waitcnt vmcnt(10)
    s_nop 0
    v_mfma_f32_16x16x32_bf16 v[8:11], v[148:151], v[36:39], v[8:11]
    v_and_b32_dpp v32, v25, v28 row_newbcast:8 row_mask:0xf bank_mask:0xf
    v_and_b32_dpp v33, v25, v29 row_newbcast:8 row_mask:0xf bank_mask:0xf
    v_and_b32_dpp v34, v25, v30 row_newbcast:8 row_mask:0xf bank_mask:0xf
    v_and_b32_dpp v35, v25, v31 row_newbcast:8 row_mask:0xf bank_mask:0xf
    s_waitcnt vmcnt(9)
    s_nop 0
    v_mfma_f32_16x16x32_bf16 v[8:11], v[152:155], v[32:35], v[8:11]
    v_and_b32_dpp v36, v25, v28 row_newbcast:12 row_mask:0xf bank_mask:0xf
    v_and_b32_dpp v37, v25, v29 row_newbcast:12 row_mask:0xf bank_mask:0xf
    v_and_b32_dpp v38, v25, v30 row_newbcast:12 row_mask:0xf bank_mask:0xf
    v_and_b32_dpp v39, v25, v31 row_newbcast:12 row_mask:0xf bank_mask:0xf
    s_waitcnt vmcnt(8)
    s_nop 0
    v_mfma_f32_16x16x32_bf16 v[8:11], v[156:159], v[36:39], v[8:11]
    v_and_b32_dpp v32, v26, v28 row_newbcast:0 row_mask:0xf bank_mask:0xf
    v_and_b32_dpp v33, v26, v29 row_newbcast:0 row_mask:0xf bank_mask:0xf
    v_and_b32_dpp v34, v26, v30 row_newbcast:0 row_mask:0xf bank_mask:0xf
    v_and_b32_dpp v35, v26, v31 row_newbcast:0 row_mask:0xf bank_mask:0xf
    s_waitcnt vmcnt(7)
    s_nop 0
    v_mfma_f32_16x16x32_bf16 v[8:11], v[160:163], v[32:35], v[8:11]
    v_and_b32_dpp v36, v26, v28 row_newbcast:4 row_mask:0xf bank_mask:0xf
    v_and_b32_dpp v37, v26, v29 row_newbcast:4 row_mask:0xf bank_mask:0xf
    v_and_b32_dpp v38, v26, v30 row_newbcast:4 row_mask:0xf bank_mask:0xf
    v_and_b32_dpp v39, v26, v31 row_newbcast:4 row_mask:0xf bank_mask:0xf
    s_waitcnt vmcnt(6)
    s_nop 0
    v_mfma_f32_16x16x32_bf16 v[8:11], v[164:167], v[36:39], v[8:11]
    v_and_b32_dpp v32, v26, v28 row_newbcast:8 row_mask:0xf bank_mask:0xf
    v_and_b32_dpp v33, v26, v29 row_newbcast:8 row_mask:0xf bank_mask:0xf
    v_and_b32_dpp v34, v26, v30 row_newbcast:8 row_mask:0xf bank_mask:0xf
    v_and_b32_dpp v35, v26, v31 row_newbcast:8 row_mask:0xf bank_mask:0xf
    s_waitcnt vmcnt(5)
    s_nop 0
    v_mfma_f32_16x16x32_bf16 v[8:11], v[168:171], v[32:35], v[8:11]
    v_and_b32_dpp v36, v26, v28 row_newbcast:12 row_mask:0xf bank_mask:0xf
    v_and_b32_dpp v37, v26, v29 row_newbcast:12 row_mask:0xf bank_mask:0xf
    v_and_b32_dpp v38, v26, v30 row_newbcast:12 row_mask:0xf bank_mask:0xf
    v_and_b32_dpp v39, v26, v31 row_newbcast:12 row_mask:0xf bank_mask:0xf
    s_waitcnt vmcnt(4)
    s_nop 0
    v_mfma_f32_16x16x32_bf16 v[8:11], v[172:175], v[36:39], v[8:11]
    v_and_b32_dpp v32, v27, v28 row_newbcast:0 row_mask:0xf bank_mask:0xf
    v_and_b32_dpp v33, v27, v29 row_newbcast:0 row_mask:0xf bank_mask:0xf
    v_and_b32_dpp v34, v27, v30 row_newbcast:0 row_mask:0xf bank_mask:0xf
    v_and_b32_dpp v35, v27, v31 row_newbcast:0 row_mask:0xf bank_mask:0xf
    s_waitcnt vmcnt(3)
    s_nop 0
    v_mfma_f32_16x16x32_bf16 v[8:11], v[176:179], v[32:35], v[8:11]
    v_and_b32_dpp v36, v27, v28 row_newbcast:4 row_mask:0xf bank_mask:0xf
    v_and_b32_dpp v37, v27, v29 row_newbcast:4 row_mask:0xf bank_mask:0xf
    v_and_b32_dpp v38, v27, v30 row_newbcast:4 row_mask:0xf bank_mask:0xf
    v_and_b32_dpp v39, v27, v31 row_newbcast:4 row_mask:0xf bank_mask:0xf
    s_waitcnt vmcnt(2)
    s_nop 0
    v_mfma_f32_16x16x32_bf16 v[8:11], v[180:183], v[36:39], v[8:11]
    v_and_b32_dpp v32, v27, v28 row_newbcast:8 row_mask:0xf bank_mask:0xf
    v_and_b32_dpp v33, v27, v29 row_newbcast:8 row_mask:0xf bank_mask:0xf
    v_and_b32_dpp v34, v27, v30 row_newbcast:8 row_mask:0xf bank_mask:0xf
    v_and_b32_dpp v35, v27, v31 row_newbcast:8 row_mask:0xf bank_mask:0xf
    s_waitcnt vmcnt(1)
    s_nop 0
    v_mfma_f32_16x16x32_bf16 v[8:11], v[184:187], v[32:35], v[8:11]
    v_and_b32_dpp v36, v27, v28 row_newbcast:12 row_mask:0xf bank_mask:0xf
    v_and_b32_dpp v37, v27, v29 row_newbcast:12 row_mask:0xf bank_mask:0xf
    v_and_b32_dpp v38, v27, v30 row_newbcast:12 row_mask:0xf bank_mask:0xf
    v_and_b32_dpp v39, v27, v31 row_newbcast:12 row_mask:0xf bank_mask:0xf
    s_waitcnt vmcnt(0)
    s_nop 0
    v_mfma_f32_16x16x32_bf16 v[8:11], v[188:191], v[36:39], v[8:11]

    v_lshrrev_b32 v3, 4, v0
    v_and_b32 v4, 7, v0
    v_lshl_add_u32 v3, v3, 5, v4
    s_lshl_b32 s63, s3, 9
    v_lshl_add_u32 v3, v3, 2, s63
    s_nop 3
    ds_write_b32 v3, v8 offset:43008
    ds_write_b32 v3, v9 offset:43040
    ds_write_b32 v3, v10 offset:43072
    ds_write_b32 v3, v11 offset:43104
    s_waitcnt lgkmcnt(0)
    s_barrier
    v_lshlrev_b32 v3, 3, v0
    ds_read_b64 v[64:65], v3 offset:43008
    ds_read_b64 v[66:67], v3 offset:43520
    ds_read_b64 v[68:69], v3 offset:44032
    ds_read_b64 v[70:71], v3 offset:44544
    ds_read_b64 v[72:73], v3 offset:45056
    ds_read_b64 v[74:75], v3 offset:45568
    ds_read_b64 v[76:77], v3 offset:46080
    ds_read_b64 v[78:79], v3 offset:46592

    v_mov_b32 v82, v60
    v_mov_b32 v83, v48
    s_waitcnt lgkmcnt(0)
    v_mul_f32 v80, v64, v52
    v_mul_f32 v81, v65, v52
    v_fmac_f32 v80, v66, v53
    v_fmac_f32 v81, v67, v53
    v_fmac_f32 v80, v68, v54
    v_fmac_f32 v81, v69, v54
    v_fmac_f32 v80, v70, v55
    v_fmac_f32 v81, v71, v55
    v_fmac_f32 v80, v72, v56
    v_fmac_f32 v81, v73, v56
    v_fmac_f32 v80, v74, v57
    v_fmac_f32 v81, v75, v57
    v_fmac_f32 v80, v76, v58
    v_fmac_f32 v81, v77, v58
    v_fmac_f32 v80, v78, v59
    v_fmac_f32 v81, v79, v59
    buffer_store_dwordx4 v[80:83], v2, s[36:39], s67 offen sc1
    buffer_load_dwordx4 v[116:119], v6, s[28:31], 0 offen nt
    buffer_load_dwordx4 v[120:123], v6, s[28:31], s62 offen nt
    buffer_load_dwordx4 v[124:127], v6, s[32:35], 0 offen nt
    buffer_load_dwordx4 v[84:87], v2, s[36:39], s68 offen offset:0 sc1
    buffer_load_dwordx4 v[88:91], v2, s[36:39], s68 offen offset:1024 sc1
    buffer_load_dwordx4 v[92:95], v2, s[36:39], s68 offen offset:2048 sc1
    buffer_load_dwordx4 v[96:99], v2, s[36:39], s68 offen offset:3072 sc1
    buffer_load_dwordx4 v[100:103], v2, s[36:39], s69 offen offset:0 sc1
    buffer_load_dwordx4 v[104:107], v2, s[36:39], s69 offen offset:1024 sc1
    buffer_load_dwordx4 v[108:111], v2, s[36:39], s69 offen offset:2048 sc1
    buffer_load_dwordx4 v[112:115], v2, s[36:39], s69 offen offset:3072 sc1

    s_lshl_b32 s63, s3, 11
    v_add_u32 v3, s63, v2
    s_lshl_b32 s63, s3, 10
    v_add_u32 v4, s63, v2
    s_waitcnt vmcnt(8)

    ds_write_b128 v3, v[116:119] offset:18432
    ds_write_b128 v3, v[120:123] offset:19456
    ds_write_b128 v4, v[124:127] offset:34816
    s_waitcnt lgkmcnt(0)
    s_barrier
    ds_read_b64_tr_b16 v[128:129], v7 offset:34816
    ds_read_b64_tr_b16 v[130:131], v7 offset:35328
    ds_read_b64_tr_b16 v[132:133], v7 offset:34848
    ds_read_b64_tr_b16 v[134:135], v7 offset:35360
    ds_read_b64_tr_b16 v[136:137], v7 offset:34880
    ds_read_b64_tr_b16 v[138:139], v7 offset:35392
    ds_read_b64_tr_b16 v[140:141], v7 offset:34912
    ds_read_b64_tr_b16 v[142:143], v7 offset:35424
    ds_read_b64_tr_b16 v[144:145], v7 offset:38912
    ds_read_b64_tr_b16 v[146:147], v7 offset:39424
    ds_read_b64_tr_b16 v[148:149], v7 offset:38944
    ds_read_b64_tr_b16 v[150:151], v7 offset:39456
    ds_read_b64_tr_b16 v[152:153], v7 offset:38976
    ds_read_b64_tr_b16 v[154:155], v7 offset:39488
    ds_read_b64_tr_b16 v[156:157], v7 offset:39008
    ds_read_b64_tr_b16 v[158:159], v7 offset:39520
    v_lshrrev_b32 v3, 4, v0
    v_lshlrev_b32 v3, 4, v3
    ds_read_b128 v[160:163], v3 offset:47872
    ds_read_b128 v[164:167], v3 offset:47936
    s_waitcnt lgkmcnt(0)
    ds_read_b64_tr_b16 v[192:193], v7 offset:18432
    ds_read_b64_tr_b16 v[194:195], v7 offset:18944
    ds_read_b64_tr_b16 v[196:197], v7 offset:18464
    ds_read_b64_tr_b16 v[198:199], v7 offset:18976
    ds_read_b64_tr_b16 v[200:201], v7 offset:18496
    ds_read_b64_tr_b16 v[202:203], v7 offset:19008
    ds_read_b64_tr_b16 v[204:205], v7 offset:18528
    ds_read_b64_tr_b16 v[206:207], v7 offset:19040
    ds_read_b64_tr_b16 v[208:209], v7 offset:22528
    ds_read_b64_tr_b16 v[210:211], v7 offset:23040
    ds_read_b64_tr_b16 v[212:213], v7 offset:22560
    ds_read_b64_tr_b16 v[214:215], v7 offset:23072
    ds_read_b64_tr_b16 v[216:217], v7 offset:22592
    ds_read_b64_tr_b16 v[218:219], v7 offset:23104
    ds_read_b64_tr_b16 v[220:221], v7 offset:22624
    ds_read_b64_tr_b16 v[222:223], v7 offset:23136
    ds_read_b64_tr_b16 v[224:225], v7 offset:26624
    ds_read_b64_tr_b16 v[226:227], v7 offset:27136
    ds_read_b64_tr_b16 v[228:229], v7 offset:26656
    ds_read_b64_tr_b16 v[230:231], v7 offset:27168
    ds_read_b64_tr_b16 v[232:233], v7 offset:26688
    ds_read_b64_tr_b16 v[234:235], v7 offset:27200
    ds_read_b64_tr_b16 v[236:237], v7 offset:26720
    ds_read_b64_tr_b16 v[238:239], v7 offset:27232
    ds_read_b64_tr_b16 v[240:241], v7 offset:30720
    ds_read_b64_tr_b16 v[242:243], v7 offset:31232
    ds_read_b64_tr_b16 v[244:245], v7 offset:30752
    ds_read_b64_tr_b16 v[246:247], v7 offset:31264
    ds_read_b64_tr_b16 v[248:249], v7 offset:30784
    ds_read_b64_tr_b16 v[250:251], v7 offset:31296
    ds_read_b64_tr_b16 v[252:253], v7 offset:30816
    ds_read_b64_tr_b16 v[254:255], v7 offset:31328
    v_mfma_f32_16x16x32_bf16 v[168:171], v[160:163], v[128:131], 0
    v_mfma_f32_16x16x32_bf16 v[172:175], v[160:163], v[132:135], 0
    v_mfma_f32_16x16x32_bf16 v[176:179], v[160:163], v[136:139], 0
    v_mfma_f32_16x16x32_bf16 v[180:183], v[160:163], v[140:143], 0
    v_mfma_f32_16x16x32_bf16 v[168:171], v[164:167], v[144:147], v[168:171]
    v_mfma_f32_16x16x32_bf16 v[172:175], v[164:167], v[148:151], v[172:175]
    v_mfma_f32_16x16x32_bf16 v[176:179], v[164:167], v[152:155], v[176:179]
    v_mfma_f32_16x16x32_bf16 v[180:183], v[164:167], v[156:159], v[180:183]
    s_nop 7
    v_cndmask_b32_e64 v61, v168, v172, s[80:81]
    v_cndmask_b32_e64 v61, v61, v176, s[82:83]
    v_cndmask_b32_e64 v61, v61, v180, s[84:85]
    s_waitcnt vmcnt(0)
    v_xor_b32 v3, v87, v48
    v_xor_b32 v4, v91, v48
    v_or_b32 v3, v3, v4
    v_xor_b32 v4, v95, v48
    v_or_b32 v3, v3, v4
    v_xor_b32 v4, v99, v48
    v_or_b32 v3, v3, v4
    v_xor_b32 v4, v103, v48
    v_or_b32 v3, v3, v4
    v_xor_b32 v4, v107, v48
    v_or_b32 v3, v3, v4
    v_xor_b32 v4, v111, v48
    v_or_b32 v3, v3, v4
    v_xor_b32 v4, v115, v48
    v_or_b32 v3, v3, v4
    v_cmp_ne_u32 vcc, 0, v3

    s_cbranch_vccz Lo_ok
    s_mov_b32 s87, 0
Lo_retry:
    buffer_load_dwordx4 v[84:87], v2, s[36:39], s68 offen offset:0 sc1
    buffer_load_dwordx4 v[88:91], v2, s[36:39], s68 offen offset:1024 sc1
    buffer_load_dwordx4 v[92:95], v2, s[36:39], s68 offen offset:2048 sc1
    buffer_load_dwordx4 v[96:99], v2, s[36:39], s68 offen offset:3072 sc1
    buffer_load_dwordx4 v[100:103], v2, s[36:39], s69 offen offset:0 sc1
    buffer_load_dwordx4 v[104:107], v2, s[36:39], s69 offen offset:1024 sc1
    buffer_load_dwordx4 v[108:111], v2, s[36:39], s69 offen offset:2048 sc1
    buffer_load_dwordx4 v[112:115], v2, s[36:39], s69 offen offset:3072 sc1
    s_add_u32 s87, s87, 1
    s_waitcnt vmcnt(0)
    v_xor_b32 v3, v87, v48
    v_xor_b32 v4, v91, v48
    v_or_b32 v3, v3, v4
    v_xor_b32 v4, v95, v48
    v_or_b32 v3, v3, v4
    v_xor_b32 v4, v99, v48
    v_or_b32 v3, v3, v4
    v_xor_b32 v4, v103, v48
    v_or_b32 v3, v3, v4
    v_xor_b32 v4, v107, v48
    v_or_b32 v3, v3, v4
    v_xor_b32 v4, v111, v48
    v_or_b32 v3, v3, v4
    v_xor_b32 v4, v115, v48
    v_or_b32 v3, v3, v4
    v_cmp_ne_u32 vcc, 0, v3

    s_cbranch_vccz Lo_ok
    s_cmp_lt_u32 s87, 0x8000
    s_cbranch_scc1 Lo_retry
Lo_ok:

    v_max3_f32 v3, v86, v90, v94
    v_max3_f32 v4, v98, v102, v106
    v_max3_f32 v3, v3, v110, v114
    v_max_f32 v3, v3, v4
    v_sub_f32 v86, v86, v3
    v_sub_f32 v90, v90, v3
    v_sub_f32 v94, v94, v3
    v_sub_f32 v98, v98, v3
    v_sub_f32 v102, v102, v3
    v_sub_f32 v106, v106, v3
    v_sub_f32 v110, v110, v3
    v_sub_f32 v114, v114, v3
    v_exp_f32 v86, v86
    v_exp_f32 v90, v90
    v_exp_f32 v94, v94
    v_exp_f32 v98, v98
    v_exp_f32 v102, v102
    v_exp_f32 v106, v106
    v_exp_f32 v110, v110
    v_exp_f32 v114, v114

    s_nop 0
    v_add_f32 v3, v86, v90
    v_add_f32 v4, v94, v98
    v_add_f32 v5, v102, v106
    v_add_f32 v62, v110, v114
    v_mul_f32 v80, v84, v86
    v_mul_f32 v81, v85, v86
    v_add_f32 v3, v3, v4
    v_add_f32 v5, v5, v62
    v_fmac_f32 v80, v88, v90
    v_fmac_f32 v81, v89, v90
    v_add_f32 v3, v3, v5
    v_fmac_f32 v80, v92, v94
    v_fmac_f32 v81, v93, v94
    v_rcp_f32 v3, v3
    v_fmac_f32 v80, v96, v98
    v_fmac_f32 v81, v97, v98
    v_fmac_f32 v80, v100, v102
    v_fmac_f32 v81, v101, v102
    v_fmac_f32 v80, v104, v106
    v_fmac_f32 v81, v105, v106
    v_fmac_f32 v80, v108, v110
    v_fmac_f32 v81, v109, v110
    v_fmac_f32 v80, v112, v114
    v_fmac_f32 v81, v113, v114

    v_mul_f32 v80, v80, v3
    v_mul_f32 v81, v81, v3
    v_lshlrev_b32 v4, 2, v0
    v_cvt_pk_bf16_f32 v80, v80, v81
    v_lshrrev_b32 v5, 4, v0
    v_lshlrev_b32 v5, 4, v5
    ds_write_b32 v4, v80 offset:48000
    ds_read_b128 v[12:15], v5 offset:48000
    ds_read_b128 v[16:19], v5 offset:48064
    ds_read_b128 v[20:23], v5 offset:48128
    ds_read_b128 v[24:27], v5 offset:48192

    v_lshrrev_b32 v3, 1, v0
    v_lshlrev_b32 v3, 10, v3
    v_and_b32 v4, 1, v0
    v_lshl_add_u32 v3, v4, 9, v3
    v_mov_b32 v81, v61
    v_mov_b32 v82, v48
    s_waitcnt lgkmcnt(0)
    v_mfma_f32_16x16x32_bf16 v[32:35], v[12:15], v[192:195], 0
    v_mfma_f32_16x16x32_bf16 v[36:39], v[12:15], v[196:199], 0
    v_mfma_f32_16x16x32_bf16 v[40:43], v[12:15], v[200:203], 0
    v_mfma_f32_16x16x32_bf16 v[44:47], v[12:15], v[204:207], 0
    v_mfma_f32_16x16x32_bf16 v[32:35], v[16:19], v[208:211], v[32:35]
    v_mfma_f32_16x16x32_bf16 v[36:39], v[16:19], v[212:215], v[36:39]
    v_mfma_f32_16x16x32_bf16 v[40:43], v[16:19], v[216:219], v[40:43]
    v_mfma_f32_16x16x32_bf16 v[44:47], v[16:19], v[220:223], v[44:47]
    v_mfma_f32_16x16x32_bf16 v[32:35], v[20:23], v[224:227], v[32:35]
    v_mfma_f32_16x16x32_bf16 v[36:39], v[20:23], v[228:231], v[36:39]
    v_mfma_f32_16x16x32_bf16 v[40:43], v[20:23], v[232:235], v[40:43]
    v_mfma_f32_16x16x32_bf16 v[44:47], v[20:23], v[236:239], v[44:47]
    v_mfma_f32_16x16x32_bf16 v[32:35], v[24:27], v[240:243], v[32:35]
    v_mfma_f32_16x16x32_bf16 v[36:39], v[24:27], v[244:247], v[36:39]
    v_mfma_f32_16x16x32_bf16 v[40:43], v[24:27], v[248:251], v[40:43]
    v_mfma_f32_16x16x32_bf16 v[44:47], v[24:27], v[252:255], v[44:47]
    s_nop 7
    v_cndmask_b32_e64 v80, v32, v36, s[80:81]
    v_cndmask_b32_e64 v80, v80, v40, s[82:83]
    v_cndmask_b32_e64 v80, v80, v44, s[84:85]
    buffer_store_dwordx3 v[80:82], v3, s[36:39], s70 offen sc1

    v_lshrrev_b32 v3, 5, v0
    v_lshlrev_b32 v3, 9, v3
    v_and_b32 v4, 31, v0
    v_lshl_add_u32 v62, v4, 4, v3
    buffer_load_dwordx4 v[84:87], v62, s[36:39], s71 offen sc1
    s_waitcnt vmcnt(0)
    v_cmp_ne_u32 vcc, v86, v48

    s_cbranch_vccz Lf_ok
    s_mov_b32 s87, 0
Lf_retry:
    buffer_load_dwordx4 v[84:87], v62, s[36:39], s71 offen sc1
    s_add_u32 s87, s87, 1
    s_waitcnt vmcnt(0)
    v_cmp_ne_u32 vcc, v86, v48

    s_cbranch_vccz Lf_ok
    s_cmp_lt_u32 s87, 0x8000
    s_cbranch_scc1 Lf_retry
Lf_ok:
    v_add_f32_dpp v84, v84, v84 row_ror:1 row_mask:0xf bank_mask:0xf
    v_add_f32_dpp v85, v85, v85 row_ror:1 row_mask:0xf bank_mask:0xf
    s_nop 0
    v_add_f32_dpp v84, v84, v84 row_ror:2 row_mask:0xf bank_mask:0xf
    v_add_f32_dpp v85, v85, v85 row_ror:2 row_mask:0xf bank_mask:0xf
    s_nop 0
    v_add_f32_dpp v84, v84, v84 row_ror:4 row_mask:0xf bank_mask:0xf
    v_add_f32_dpp v85, v85, v85 row_ror:4 row_mask:0xf bank_mask:0xf
    s_nop 0
    v_add_f32_dpp v84, v84, v84 row_ror:8 row_mask:0xf bank_mask:0xf
    v_add_f32_dpp v85, v85, v85 row_ror:8 row_mask:0xf bank_mask:0xf
    s_nop 0

    v_add_f32_dpp v84, v84, v84 row_bcast:15 row_mask:0xa bank_mask:0xf
    v_add_f32_dpp v85, v85, v85 row_bcast:15 row_mask:0xa bank_mask:0xf
    v_lshlrev_b32 v51, 16, v51
    v_lshlrev_b32 v50, 16, v50
    v_cvt_pk_bf16_f32 v85, v85, v85
    v_and_b32 v85, 0xffff0000, v85
    v_cvt_pk_bf16_f32 v84, v84, v84
    v_and_b32 v84, 0xffff0000, v84
    v_add_f32 v85, v85, v51
    v_cvt_pk_bf16_f32 v85, v85, v85
    v_and_b32 v85, 0xffff0000, v85

    v_mul_f32 v86, 0xbfb8aa3b, v85
    v_exp_f32 v86, v86
    s_nop 0
    v_add_f32 v86, 1.0, v86
    v_rcp_f32 v86, v86
    s_nop 0
    v_mul_f32 v86, v85, v86
    v_cvt_pk_bf16_f32 v86, v86, v86
    v_and_b32 v86, 0xffff0000, v86
    v_mul_f32 v84, v84, v86
    v_cvt_pk_bf16_f32 v84, v84, v84
    v_and_b32 v84, 0xffff0000, v84

    v_add_f32 v84, v84, v50
    v_cvt_pk_bf16_f32 v84, v84, v84
    v_lshrrev_b32 v3, 5, v0
    v_lshlrev_b32 v3, 1, v3
    s_lshl_b32 s63, s2, 2
    s_mov_b32 exec_lo, 0x80000000
    s_mov_b32 exec_hi, 0x80000000
    buffer_store_short v84, v3, s[48:51], s63 offen
    s_cmp_lg_u32 s2, 0
    s_cbranch_scc1 L0_noepoch
    s_mov_b64 exec, 1
    v_mov_b32 v4, 0
    buffer_store_dword v48, v4, s[36:39], 0 offen sc1
L0_noepoch:
    s_mov_b64 exec, -1
    s_endpgm
L_end:
    s_endpgm

.section .rodata,"a"
.p2align 6
.amdhsa_kernel recurrent_scan__gqa_block_cached__mixer_channel_mlp__decode_kernel
  .amdhsa_next_free_vgpr 256
  .amdhsa_next_free_sgpr 102
  .amdhsa_accum_offset 256
  .amdhsa_group_segment_fixed_size 0
  .amdhsa_kernarg_size 104
  .amdhsa_user_sgpr_count 2
  .amdhsa_user_sgpr_kernarg_segment_ptr 1
  .amdhsa_system_sgpr_workgroup_id_x 1
.end_amdhsa_kernel
```
